```python
import torch

def _softmax(x, axis=-1):
    return torch.softmax(x, dim=axis)

def _gelu(x):
    return torch.nn.functional.gelu(x, approximate='tanh')

def _silu(x):
    return torch.nn.functional.silu(x)

def _sigmoid(x):
    return torch.sigmoid(x)

def _layernorm(x, axis=-1, eps=1e-05):
    m = x.mean(dim=axis, keepdim=True)
    v = x.var(dim=axis, keepdim=True, unbiased=False)
    return (x - m) / torch.sqrt(v + eps)

def _scatter_add(tgt, idx, src, axis=0):
    return tgt.clone().index_add_(axis, idx, src)

def _segment_sum(src, seg, n):
    out = torch.zeros((n,) + src.shape[1:], dtype=src.dtype)
    return out.index_add_(0, seg, src)

def _pad(x, pw):
    flat = tuple((v for pair in reversed(pw) for v in pair))
    return torch.nn.functional.pad(x, flat)
kernel_name = 'adaLN_cond__mha_block_cached__swiglu_ffn__decode'

def setup_inputs():

    _w = lambda a: (lambda t: t.to(torch.bfloat16) if t.is_floating_point() else t)(torch.as_tensor(a))

    def _A_setup():
        B, Sq, D = (1, 1, 640)
        H, Sk, Dh = (32, 32768, 192)
        return {'x': _w((lambda *s: torch.randn(*s, dtype=torch.bfloat16) * 0.1)(B, Sq, D)), 'k_cache': _w((lambda *s: torch.randn(*s, dtype=torch.bfloat16) * 0.8)(B, H, Sk, Dh)), 'v_cache': _w((lambda *s: torch.randn(*s, dtype=torch.bfloat16) * 0.8)(B, H, Sk, Dh)), 'wq': _w((lambda *s: torch.randn(*s, dtype=torch.bfloat16) * 0.8)(D, H * Dh) * D ** (-0.5)), 'wo': _w((lambda *s: torch.randn(*s, dtype=torch.bfloat16) * 0.8)(H * Dh, D) * (H * Dh) ** (-0.5))}
    _A_in = _A_setup()

    def _B_setup():
        B, S, D, F = (1, 1, 640, 1536)
        return {'x': _w((lambda *s: torch.randn(*s, dtype=torch.bfloat16) * 0.1)(B, S, D)), 'w_gate': _w((lambda *s: torch.randn(*s, dtype=torch.bfloat16) * 0.1)(D, F)), 'w_up': _w((lambda *s: torch.randn(*s, dtype=torch.bfloat16) * 0.1)(D, F)), 'w_down': _w((lambda *s: torch.randn(*s, dtype=torch.bfloat16) * 0.1)(F, D))}
    _B_in = _B_setup()
    return {'A_x': _A_in['x'], 'A_k_cache': _A_in['k_cache'], 'A_v_cache': _A_in['v_cache'], 'A_wq': _A_in['wq'], 'A_wo': _A_in['wo'], 'B_x': _B_in['x'], 'B_w_gate': _B_in['w_gate'], 'B_w_up': _B_in['w_up'], 'B_w_down': _B_in['w_down'], 'c': _w((lambda *s: torch.randn(*s, dtype=torch.bfloat16) * 0.8)(1, 640) * 8.0), 'w_mod': _w((lambda *s: torch.randn(*s, dtype=torch.bfloat16) * 0.8)(640, 6 * 640) * 640 ** (-0.5) * 8.0)}

def reference(A_x, A_k_cache, A_v_cache, A_wq, A_wo, B_x, B_w_gate, B_w_up, B_w_down, c, w_mod):

    def _A_ref(x, k_cache, v_cache, wq, wo):
        B, Sq, D = x.shape
        H, Dh = (32, 192)
        q = (lambda x, *d: x.permute(*d))((x @ wq).reshape(B, Sq, H, Dh), 0, 2, 1, 3)
        scores = torch.einsum('bhqd,bhkd->bhqk', q, k_cache) * Dh ** (-0.5)
        p = _softmax(scores, axis=-1)
        o = torch.einsum('bhqk,bhkd->bhqd', p, v_cache)
        return (lambda x, *d: x.permute(*d))(o, 0, 2, 1, 3).reshape(B, Sq, H * Dh) @ wo

    def _B_ref(x, w_gate, w_up, w_down):
        g = _silu(x @ w_gate)
        u = x @ w_up
        return g * u @ w_down
    x = A_x
    mod = (_silu(c) @ w_mod).reshape(c.shape[0], 6, 1, -1)
    sa, ca, ga, sb, cb, gb = (mod[:, 0].clone(), mod[:, 1].clone(), mod[:, 2].clone(), mod[:, 3].clone(), mod[:, 4].clone(), mod[:, 5].clone())
    h = _layernorm(x, axis=-1) * (1 + ca) + sa
    x = x + ga * _A_ref(h, A_k_cache, A_v_cache, A_wq, A_wo)
    h = _layernorm(x, axis=-1) * (1 + cb) + sb
    x = x + gb * _B_ref(h, B_w_gate, B_w_up, B_w_down)
    return x
```

```asm
; @launch grid=(256,1,1) block=(512,1,1) lds=163840
.amdgcn_target "amdgcn-amd-amdhsa--gfx950"
.text
.globl adaLN_cond__mha_block_cached__swiglu_ffn__decode_kernel
.p2align 8
.type adaLN_cond__mha_block_cached__swiglu_ffn__decode_kernel,@function
adaLN_cond__mha_block_cached__swiglu_ffn__decode_kernel:
    s_cmp_ge_u32 s2, 256
    s_cbranch_scc1 .Lend
    s_load_dwordx8 s[72:79], s[0:1], 0
    s_load_dwordx8 s[80:87], s[0:1], 32
    s_load_dwordx8 s[88:95], s[0:1], 64
    s_load_dwordx4 s[96:99], s[0:1], 96
    v_lshrrev_b32 v1, 6, v0
    s_nop 0
    v_readfirstlane_b32 s20, v1
    v_and_b32 v1, 63, v0
    s_lshr_b32 s25, s2, 4
    s_and_b32 s26, s2, 15
    s_getpc_b64 s[28:29]
    s_and_b32 s28, s28, 0xffffff00
    v_lshlrev_b32 v2, 4, v0
    v_min_u32 v3, .Lend-adaLN_cond__mha_block_cached__swiglu_ffn__decode_kernel-12, v2
    global_load_dwordx4 v[252:255], v3, s[28:29]
    v_add_u32 v2, 0x2000, v2
    v_min_u32 v3, .Lend-adaLN_cond__mha_block_cached__swiglu_ffn__decode_kernel-12, v2
    global_load_dwordx4 v[252:255], v3, s[28:29]
    v_add_u32 v2, 0x2000, v2
    v_min_u32 v3, .Lend-adaLN_cond__mha_block_cached__swiglu_ffn__decode_kernel-12, v2
    global_load_dwordx4 v[252:255], v3, s[28:29]
    v_add_u32 v2, 0x2000, v2
    v_min_u32 v3, .Lend-adaLN_cond__mha_block_cached__swiglu_ffn__decode_kernel-12, v2
    global_load_dwordx4 v[252:255], v3, s[28:29]
    v_add_u32 v2, 0x2000, v2
    v_min_u32 v3, .Lend-adaLN_cond__mha_block_cached__swiglu_ffn__decode_kernel-12, v2
    global_load_dwordx4 v[252:255], v3, s[28:29]
    v_add_u32 v2, 0x2000, v2
    s_waitcnt lgkmcnt(0)
    s_mov_b32 s8, s98
    s_mov_b32 s9, s99
    s_mov_b32 s10, 2097152
    s_mov_b32 s11, 0x00020000
    s_mov_b32 s12, s96
    s_mov_b32 s13, s97
    s_mov_b32 s14, 256
    s_mov_b32 s15, 0x00020000
    s_mov_b32 s16, s74
    s_mov_b32 s17, s75
    s_mov_b32 s18, s76
    s_mov_b32 s19, s77
    s_cmp_lt_u32 s20, 4
    s_cbranch_scc1 .Lstream
.Laux:
    s_setprio 3
    s_sub_u32 s27, s20, 4
    v_mov_b32 v52, 0
    v_lshlrev_b32 v2, 1, v1
    v_lshlrev_b32 v3, 2, v1
    s_cmp_lg_u32 s27, 0
    s_cbranch_scc1 .Lnosync
    v_mov_b32 v8, 162816
    v_mov_b32 v10, 0
    v_mov_b32 v11, 0
    ds_write_b64 v8, v[10:11]
    ds_write_b64 v8, v[10:11] offset:8
    ds_write_b64 v8, v[10:11] offset:16
    ds_write_b64 v8, v[10:11] offset:24
    v_mov_b32 v11, 0x7fffffff
    ds_write_b32 v8, v11 offset:28
    v_mov_b32 v11, 0
    v_mov_b32 v8, 160512
    ds_write_b64 v8, v[10:11]
    s_waitcnt lgkmcnt(0)
.Lnosync:
    s_barrier
    s_cmp_lg_u32 s2, 0
    s_cbranch_scc1 .Lnononce
    s_cmp_lg_u32 s27, 0
    s_cbranch_scc1 .Lnononce
    s_memrealtime s[70:71]
    s_waitcnt lgkmcnt(0)
    s_or_b32 s70, s70, 1
    v_mov_b32 v9, s70
    s_mov_b64 exec, 1
    buffer_store_dword v9, v52, s[12:15], 0 offen sc0 sc1
    s_mov_b64 exec, -1
.Lnononce:
    s_mov_b32 s44, s72
    s_mov_b32 s45, s73
    s_mov_b32 s46, 1280
    s_mov_b32 s47, 0x00020000
    s_mov_b32 s48, s90
    s_mov_b32 s49, s91
    s_mov_b32 s50, 1280
    s_mov_b32 s51, 0x00020000
    s_mov_b32 s52, s92
    s_mov_b32 s53, s93
    s_mov_b32 s54, 4915200
    s_mov_b32 s55, 0x00020000
    s_mov_b32 s56, s78
    s_mov_b32 s57, s79
    s_mov_b32 s58, 7864320
    s_mov_b32 s59, 0x00020000
    v_lshrrev_b32 v4, 2, v1
    v_and_b32 v5, 3, v1
    s_mul_i32 s28, s27, 160
    v_add_u32 v6, s28, v4
    v_lshlrev_b32 v7, 1, v6
    v_lshlrev_b32 v14, 2, v6
    s_cmp_lg_u32 s27, 0
    s_cbranch_scc1 .Lnoclear
    v_mov_b32 v9, -1
    s_mov_b64 exec, 0xffffffff
    s_cmp_ge_u32 s2, 120
    s_cbranch_scc1 .Lclr1
    s_lshl_b32 s28, s2, 7
    buffer_store_dword v9, v3, s[8:11], s28 offen offset:0 sc0 sc1
.Lclr1:
.Lclr2:
    s_mov_b64 exec, 0xff
    s_lshl_b32 s28, s25, 10
    s_lshl_b32 s29, s26, 5
    s_add_u32 s28, s28, s29
    s_add_u32 s28, s28, 32768
    buffer_store_dword v9, v3, s[8:11], s28 offen sc0 sc1
    buffer_store_dword v9, v3, s[8:11], s28 offen offset:512 sc0 sc1
    s_mov_b64 exec, -1
    s_mul_i32 s28, s2, 1536
    s_add_u32 s28, s28, 65536
    v_lshlrev_b32 v8, 4, v1
    v_mov_b32 v10, -1
    v_mov_b32 v11, -1
    v_mov_b32 v12, -1
    v_mov_b32 v13, -1
    buffer_store_dwordx4 v[10:13], v8, s[8:11], s28 offen sc0 sc1
    s_mov_b64 exec, 0xffffffff
    buffer_store_dwordx4 v[10:13], v8, s[8:11], s28 offen offset:1024 sc0 sc1
    s_mov_b64 exec, -1
    s_cmp_ge_u32 s2, 160
    s_cbranch_scc1 .Lclr3
    s_lshl_b32 s28, s2, 8
    s_add_u32 s28, s28, 458752
    buffer_store_dword v9, v3, s[8:11], s28 offen sc0 sc1
    s_branch .Lclr4
.Lclr3:
    s_sub_u32 s28, s2, 160
    s_cmp_ge_u32 s28, 48
    s_cbranch_scc1 .Lclr4
    s_mov_b64 exec, 0xffffffff
    s_lshl_b32 s28, s28, 7
    s_add_u32 s28, s28, 499712
    buffer_store_dword v9, v3, s[8:11], s28 offen sc0 sc1
    s_mov_b64 exec, -1
.Lclr4:
    buffer_load_dword v62, v52, s[12:15], 0 offen sc1
.Lnoclear:
    s_cmp_ge_u32 s2, 64
    s_cbranch_scc1 .Lld_q
    buffer_load_ushort v16, v7, s[48:51], 0 offen offset:0
    buffer_load_ushort v17, v7, s[48:51], 0 offen offset:32
    buffer_load_ushort v18, v7, s[48:51], 0 offen offset:64
    buffer_load_ushort v19, v7, s[48:51], 0 offen offset:96
    buffer_load_ushort v20, v7, s[48:51], 0 offen offset:128
    buffer_load_ushort v21, v7, s[48:51], 0 offen offset:160
    buffer_load_ushort v22, v7, s[48:51], 0 offen offset:192
    buffer_load_ushort v23, v7, s[48:51], 0 offen offset:224
    buffer_load_ushort v24, v7, s[48:51], 0 offen offset:256
    buffer_load_ushort v25, v7, s[48:51], 0 offen offset:288
    v_mul_u32_u24 v8, 7680, v6
    v_lshl_add_u32 v8, v5, 4, v8
    s_lshl_b32 s28, s2, 6
    buffer_load_dwordx4 v[64:67], v8, s[52:55], s28 offen
    s_add_u32 s28, s28, 122880
    buffer_load_dwordx4 v[68:71], v8, s[52:55], s28 offen
    s_add_u32 s28, s28, 122880
    buffer_load_dwordx4 v[72:75], v8, s[52:55], s28 offen
    s_add_u32 s28, s28, 122880
    buffer_load_dwordx4 v[76:79], v8, s[52:55], s28 offen
    s_add_u32 s28, s28, 122880
    buffer_load_dwordx4 v[80:83], v8, s[52:55], s28 offen
    s_add_u32 s28, s28, 122880
    buffer_load_dwordx4 v[84:87], v8, s[52:55], s28 offen
    s_add_u32 s28, s28, 122880
    buffer_load_dwordx4 v[88:91], v8, s[52:55], s28 offen
    s_add_u32 s28, s28, 122880
    buffer_load_dwordx4 v[92:95], v8, s[52:55], s28 offen
    s_add_u32 s28, s28, 122880
    buffer_load_dwordx4 v[96:99], v8, s[52:55], s28 offen
    s_add_u32 s28, s28, 122880
    buffer_load_dwordx4 v[100:103], v8, s[52:55], s28 offen
    s_add_u32 s28, s28, 122880
    s_branch .Lld_done20
.Lld_q:
    buffer_load_ushort v16, v7, s[44:47], 0 offen offset:0
    buffer_load_ushort v17, v7, s[44:47], 0 offen offset:32
    buffer_load_ushort v18, v7, s[44:47], 0 offen offset:64
    buffer_load_ushort v19, v7, s[44:47], 0 offen offset:96
    buffer_load_ushort v20, v7, s[44:47], 0 offen offset:128
    buffer_load_ushort v21, v7, s[44:47], 0 offen offset:160
    buffer_load_ushort v22, v7, s[44:47], 0 offen offset:192
    buffer_load_ushort v23, v7, s[44:47], 0 offen offset:224
    buffer_load_ushort v24, v7, s[44:47], 0 offen offset:256
    buffer_load_ushort v25, v7, s[44:47], 0 offen offset:288
    buffer_load_ushort v28, v2, s[44:47], 0 offen offset:0
    buffer_load_ushort v29, v2, s[44:47], 0 offen offset:128
    buffer_load_ushort v30, v2, s[44:47], 0 offen offset:256
    buffer_load_ushort v31, v2, s[44:47], 0 offen offset:384
    buffer_load_ushort v32, v2, s[44:47], 0 offen offset:512
    buffer_load_ushort v33, v2, s[44:47], 0 offen offset:640
    buffer_load_ushort v34, v2, s[44:47], 0 offen offset:768
    buffer_load_ushort v35, v2, s[44:47], 0 offen offset:896
    buffer_load_ushort v36, v2, s[44:47], 0 offen offset:1024
    buffer_load_ushort v37, v2, s[44:47], 0 offen offset:1152
    v_mul_u32_u24 v8, 12288, v6
    v_lshl_add_u32 v8, v5, 4, v8
    s_sub_u32 s28, s2, 64
    s_lshl_b32 s28, s28, 6
    buffer_load_dwordx4 v[104:107], v8, s[56:59], s28 offen
    s_add_u32 s28, s28, 196608
    buffer_load_dwordx4 v[108:111], v8, s[56:59], s28 offen
    s_add_u32 s28, s28, 196608
    buffer_load_dwordx4 v[112:115], v8, s[56:59], s28 offen
    s_add_u32 s28, s28, 196608
    buffer_load_dwordx4 v[116:119], v8, s[56:59], s28 offen
    s_add_u32 s28, s28, 196608
    buffer_load_dwordx4 v[120:123], v8, s[56:59], s28 offen
    s_add_u32 s28, s28, 196608
    buffer_load_dwordx4 v[124:127], v8, s[56:59], s28 offen
    s_add_u32 s28, s28, 196608
    buffer_load_dwordx4 v[128:131], v8, s[56:59], s28 offen
    s_add_u32 s28, s28, 196608
    buffer_load_dwordx4 v[132:135], v8, s[56:59], s28 offen
    s_add_u32 s28, s28, 196608
    buffer_load_dwordx4 v[136:139], v8, s[56:59], s28 offen
    s_add_u32 s28, s28, 196608
    buffer_load_dwordx4 v[140:143], v8, s[56:59], s28 offen
    s_add_u32 s28, s28, 196608
.Lld_done:
    s_waitcnt vmcnt(30)
.Lld_done20:
    s_waitcnt vmcnt(20)
    s_cmp_lg_u32 s27, 0
    s_cbranch_scc1 .Lnoatom
    v_mov_b32 v9, 1
    s_mov_b64 exec, 1
    buffer_atomic_add v9, v52, s[12:15], 0 offen offset:128 sc1
    s_mov_b64 exec, -1
    v_readfirstlane_b32 s70, v62
    s_nop 0
    s_cmp_lg_u32 s70, 0
    s_cbranch_scc1 .Lhavenonce
    s_mov_b32 s39, 0
.gn_1:
    buffer_load_dword v9, v52, s[12:15], 0 offen sc1
    s_waitcnt vmcnt(0)
    v_readfirstlane_b32 s70, v9
    s_nop 0
    s_cmp_lg_u32 s70, 0
    s_cbranch_scc1 .gnd_2
    s_add_u32 s39, s39, 1
    s_cmp_gt_u32 s39, 400000
    s_cbranch_scc1 .gnd_2
    s_sleep 2
    s_branch .gn_1
.gnd_2:
.Lhavenonce:
    s_getreg_b32 s28, hwreg(HW_REG_XCC_ID)
    s_and_b32 s69, s28, 1
    v_mov_b32 v10, s69
    v_mov_b32 v11, s70
    s_lshl_b32 s28, s2, 3
    s_add_u32 s28, s28, 61440
    s_mov_b64 exec, 1
    buffer_store_dwordx2 v[10:11], v52, s[8:11], s28 offen sc1
    s_mov_b64 exec, -1
.Lnoatom:
    s_cmp_ge_u32 s2, 64
    s_cbranch_scc1 .Lp1_q
    s_waitcnt vmcnt(10)
    v_lshlrev_b32 v16, 16, v16
    v_mov_b32 v11, 0x200
    v_mul_f32 v8, 0xbfb8aa3b, v16
    v_exp_f32 v8, v8
    s_nop 0
    v_add_f32 v8, 1.0, v8
    v_cmp_class_f32 vcc, v8, v11
    v_rcp_f32 v9, v8
    s_nop 0
    v_mul_f32 v10, v16, v9
    v_fma_f32 v8, -v10, v8, v16
    v_fma_f32 v16, v8, v9, v10
    v_cndmask_b32 v16, v16, v10, vcc
    v_cvt_pk_bf16_f32 v8, v16, v16
    v_lshlrev_b32 v16, 16, v8
    v_lshlrev_b32 v17, 16, v17
    v_mov_b32 v11, 0x200
    v_mul_f32 v8, 0xbfb8aa3b, v17
    v_exp_f32 v8, v8
    s_nop 0
    v_add_f32 v8, 1.0, v8
    v_cmp_class_f32 vcc, v8, v11
    v_rcp_f32 v9, v8
    s_nop 0
    v_mul_f32 v10, v17, v9
    v_fma_f32 v8, -v10, v8, v17
    v_fma_f32 v17, v8, v9, v10
    v_cndmask_b32 v17, v17, v10, vcc
    v_cvt_pk_bf16_f32 v8, v17, v17
    v_lshlrev_b32 v17, 16, v8
    v_lshlrev_b32 v18, 16, v18
    v_mov_b32 v11, 0x200
    v_mul_f32 v8, 0xbfb8aa3b, v18
    v_exp_f32 v8, v8
    s_nop 0
    v_add_f32 v8, 1.0, v8
    v_cmp_class_f32 vcc, v8, v11
    v_rcp_f32 v9, v8
    s_nop 0
    v_mul_f32 v10, v18, v9
    v_fma_f32 v8, -v10, v8, v18
    v_fma_f32 v18, v8, v9, v10
    v_cndmask_b32 v18, v18, v10, vcc
    v_cvt_pk_bf16_f32 v8, v18, v18
    v_lshlrev_b32 v18, 16, v8
    v_lshlrev_b32 v19, 16, v19
    v_mov_b32 v11, 0x200
    v_mul_f32 v8, 0xbfb8aa3b, v19
    v_exp_f32 v8, v8
    s_nop 0
    v_add_f32 v8, 1.0, v8
    v_cmp_class_f32 vcc, v8, v11
    v_rcp_f32 v9, v8
    s_nop 0
    v_mul_f32 v10, v19, v9
    v_fma_f32 v8, -v10, v8, v19
    v_fma_f32 v19, v8, v9, v10
    v_cndmask_b32 v19, v19, v10, vcc
    v_cvt_pk_bf16_f32 v8, v19, v19
    v_lshlrev_b32 v19, 16, v8
    v_lshlrev_b32 v20, 16, v20
    v_mov_b32 v11, 0x200
    v_mul_f32 v8, 0xbfb8aa3b, v20
    v_exp_f32 v8, v8
    s_nop 0
    v_add_f32 v8, 1.0, v8
    v_cmp_class_f32 vcc, v8, v11
    v_rcp_f32 v9, v8
    s_nop 0
    v_mul_f32 v10, v20, v9
    v_fma_f32 v8, -v10, v8, v20
    v_fma_f32 v20, v8, v9, v10
    v_cndmask_b32 v20, v20, v10, vcc
    v_cvt_pk_bf16_f32 v8, v20, v20
    v_lshlrev_b32 v20, 16, v8
    v_lshlrev_b32 v21, 16, v21
    v_mov_b32 v11, 0x200
    v_mul_f32 v8, 0xbfb8aa3b, v21
    v_exp_f32 v8, v8
    s_nop 0
    v_add_f32 v8, 1.0, v8
    v_cmp_class_f32 vcc, v8, v11
    v_rcp_f32 v9, v8
    s_nop 0
    v_mul_f32 v10, v21, v9
    v_fma_f32 v8, -v10, v8, v21
    v_fma_f32 v21, v8, v9, v10
    v_cndmask_b32 v21, v21, v10, vcc
    v_cvt_pk_bf16_f32 v8, v21, v21
    v_lshlrev_b32 v21, 16, v8
    v_lshlrev_b32 v22, 16, v22
    v_mov_b32 v11, 0x200
    v_mul_f32 v8, 0xbfb8aa3b, v22
    v_exp_f32 v8, v8
    s_nop 0
    v_add_f32 v8, 1.0, v8
    v_cmp_class_f32 vcc, v8, v11
    v_rcp_f32 v9, v8
    s_nop 0
    v_mul_f32 v10, v22, v9
    v_fma_f32 v8, -v10, v8, v22
    v_fma_f32 v22, v8, v9, v10
    v_cndmask_b32 v22, v22, v10, vcc
    v_cvt_pk_bf16_f32 v8, v22, v22
    v_lshlrev_b32 v22, 16, v8
    v_lshlrev_b32 v23, 16, v23
    v_mov_b32 v11, 0x200
    v_mul_f32 v8, 0xbfb8aa3b, v23
    v_exp_f32 v8, v8
    s_nop 0
    v_add_f32 v8, 1.0, v8
    v_cmp_class_f32 vcc, v8, v11
    v_rcp_f32 v9, v8
    s_nop 0
    v_mul_f32 v10, v23, v9
    v_fma_f32 v8, -v10, v8, v23
    v_fma_f32 v23, v8, v9, v10
    v_cndmask_b32 v23, v23, v10, vcc
    v_cvt_pk_bf16_f32 v8, v23, v23
    v_lshlrev_b32 v23, 16, v8
    v_lshlrev_b32 v24, 16, v24
    v_mov_b32 v11, 0x200
    v_mul_f32 v8, 0xbfb8aa3b, v24
    v_exp_f32 v8, v8
    s_nop 0
    v_add_f32 v8, 1.0, v8
    v_cmp_class_f32 vcc, v8, v11
    v_rcp_f32 v9, v8
    s_nop 0
    v_mul_f32 v10, v24, v9
    v_fma_f32 v8, -v10, v8, v24
    v_fma_f32 v24, v8, v9, v10
    v_cndmask_b32 v24, v24, v10, vcc
    v_cvt_pk_bf16_f32 v8, v24, v24
    v_lshlrev_b32 v24, 16, v8
    v_lshlrev_b32 v25, 16, v25
    v_mov_b32 v11, 0x200
    v_mul_f32 v8, 0xbfb8aa3b, v25
    v_exp_f32 v8, v8
    s_nop 0
    v_add_f32 v8, 1.0, v8
    v_cmp_class_f32 vcc, v8, v11
    v_rcp_f32 v9, v8
    s_nop 0
    v_mul_f32 v10, v25, v9
    v_fma_f32 v8, -v10, v8, v25
    v_fma_f32 v25, v8, v9, v10
    v_cndmask_b32 v25, v25, v10, vcc
    v_cvt_pk_bf16_f32 v8, v25, v25
    v_lshlrev_b32 v25, 16, v8
    s_waitcnt vmcnt(0)
    v_mov_b32 v8, 162828
    v_mov_b32 v9, 1
    s_mov_b64 exec, 1
    ds_add_u32 v8, v9
    s_mov_b64 exec, -1
    v_lshlrev_b32 v8, 16, v64
    v_and_b32 v9, 0xffff0000, v64
    v_mul_f32 v40, v16, v8
    v_mul_f32 v41, v16, v9
    v_lshlrev_b32 v8, 16, v65
    v_and_b32 v9, 0xffff0000, v65
    v_mul_f32 v42, v16, v8
    v_mul_f32 v43, v16, v9
    v_lshlrev_b32 v8, 16, v66
    v_and_b32 v9, 0xffff0000, v66
    v_mul_f32 v44, v16, v8
    v_mul_f32 v45, v16, v9
    v_lshlrev_b32 v8, 16, v67
    v_and_b32 v9, 0xffff0000, v67
    v_mul_f32 v46, v16, v8
    v_mul_f32 v47, v16, v9
    v_lshlrev_b32 v8, 16, v68
    v_and_b32 v9, 0xffff0000, v68
    v_fmac_f32 v40, v17, v8
    v_fmac_f32 v41, v17, v9
    v_lshlrev_b32 v8, 16, v69
    v_and_b32 v9, 0xffff0000, v69
    v_fmac_f32 v42, v17, v8
    v_fmac_f32 v43, v17, v9
    v_lshlrev_b32 v8, 16, v70
    v_and_b32 v9, 0xffff0000, v70
    v_fmac_f32 v44, v17, v8
    v_fmac_f32 v45, v17, v9
    v_lshlrev_b32 v8, 16, v71
    v_and_b32 v9, 0xffff0000, v71
    v_fmac_f32 v46, v17, v8
    v_fmac_f32 v47, v17, v9
    v_lshlrev_b32 v8, 16, v72
    v_and_b32 v9, 0xffff0000, v72
    v_fmac_f32 v40, v18, v8
    v_fmac_f32 v41, v18, v9
    v_lshlrev_b32 v8, 16, v73
    v_and_b32 v9, 0xffff0000, v73
    v_fmac_f32 v42, v18, v8
    v_fmac_f32 v43, v18, v9
    v_lshlrev_b32 v8, 16, v74
    v_and_b32 v9, 0xffff0000, v74
    v_fmac_f32 v44, v18, v8
    v_fmac_f32 v45, v18, v9
    v_lshlrev_b32 v8, 16, v75
    v_and_b32 v9, 0xffff0000, v75
    v_fmac_f32 v46, v18, v8
    v_fmac_f32 v47, v18, v9
    v_lshlrev_b32 v8, 16, v76
    v_and_b32 v9, 0xffff0000, v76
    v_fmac_f32 v40, v19, v8
    v_fmac_f32 v41, v19, v9
    v_lshlrev_b32 v8, 16, v77
    v_and_b32 v9, 0xffff0000, v77
    v_fmac_f32 v42, v19, v8
    v_fmac_f32 v43, v19, v9
    v_lshlrev_b32 v8, 16, v78
    v_and_b32 v9, 0xffff0000, v78
    v_fmac_f32 v44, v19, v8
    v_fmac_f32 v45, v19, v9
    v_lshlrev_b32 v8, 16, v79
    v_and_b32 v9, 0xffff0000, v79
    v_fmac_f32 v46, v19, v8
    v_fmac_f32 v47, v19, v9
    v_lshlrev_b32 v8, 16, v80
    v_and_b32 v9, 0xffff0000, v80
    v_fmac_f32 v40, v20, v8
    v_fmac_f32 v41, v20, v9
    v_lshlrev_b32 v8, 16, v81
    v_and_b32 v9, 0xffff0000, v81
    v_fmac_f32 v42, v20, v8
    v_fmac_f32 v43, v20, v9
    v_lshlrev_b32 v8, 16, v82
    v_and_b32 v9, 0xffff0000, v82
    v_fmac_f32 v44, v20, v8
    v_fmac_f32 v45, v20, v9
    v_lshlrev_b32 v8, 16, v83
    v_and_b32 v9, 0xffff0000, v83
    v_fmac_f32 v46, v20, v8
    v_fmac_f32 v47, v20, v9
    v_lshlrev_b32 v8, 16, v84
    v_and_b32 v9, 0xffff0000, v84
    v_fmac_f32 v40, v21, v8
    v_fmac_f32 v41, v21, v9
    v_lshlrev_b32 v8, 16, v85
    v_and_b32 v9, 0xffff0000, v85
    v_fmac_f32 v42, v21, v8
    v_fmac_f32 v43, v21, v9
    v_lshlrev_b32 v8, 16, v86
    v_and_b32 v9, 0xffff0000, v86
    v_fmac_f32 v44, v21, v8
    v_fmac_f32 v45, v21, v9
    v_lshlrev_b32 v8, 16, v87
    v_and_b32 v9, 0xffff0000, v87
    v_fmac_f32 v46, v21, v8
    v_fmac_f32 v47, v21, v9
    v_lshlrev_b32 v8, 16, v88
    v_and_b32 v9, 0xffff0000, v88
    v_fmac_f32 v40, v22, v8
    v_fmac_f32 v41, v22, v9
    v_lshlrev_b32 v8, 16, v89
    v_and_b32 v9, 0xffff0000, v89
    v_fmac_f32 v42, v22, v8
    v_fmac_f32 v43, v22, v9
    v_lshlrev_b32 v8, 16, v90
    v_and_b32 v9, 0xffff0000, v90
    v_fmac_f32 v44, v22, v8
    v_fmac_f32 v45, v22, v9
    v_lshlrev_b32 v8, 16, v91
    v_and_b32 v9, 0xffff0000, v91
    v_fmac_f32 v46, v22, v8
    v_fmac_f32 v47, v22, v9
    v_lshlrev_b32 v8, 16, v92
    v_and_b32 v9, 0xffff0000, v92
    v_fmac_f32 v40, v23, v8
    v_fmac_f32 v41, v23, v9
    v_lshlrev_b32 v8, 16, v93
    v_and_b32 v9, 0xffff0000, v93
    v_fmac_f32 v42, v23, v8
    v_fmac_f32 v43, v23, v9
    v_lshlrev_b32 v8, 16, v94
    v_and_b32 v9, 0xffff0000, v94
    v_fmac_f32 v44, v23, v8
    v_fmac_f32 v45, v23, v9
    v_lshlrev_b32 v8, 16, v95
    v_and_b32 v9, 0xffff0000, v95
    v_fmac_f32 v46, v23, v8
    v_fmac_f32 v47, v23, v9
    v_lshlrev_b32 v8, 16, v96
    v_and_b32 v9, 0xffff0000, v96
    v_fmac_f32 v40, v24, v8
    v_fmac_f32 v41, v24, v9
    v_lshlrev_b32 v8, 16, v97
    v_and_b32 v9, 0xffff0000, v97
    v_fmac_f32 v42, v24, v8
    v_fmac_f32 v43, v24, v9
    v_lshlrev_b32 v8, 16, v98
    v_and_b32 v9, 0xffff0000, v98
    v_fmac_f32 v44, v24, v8
    v_fmac_f32 v45, v24, v9
    v_lshlrev_b32 v8, 16, v99
    v_and_b32 v9, 0xffff0000, v99
    v_fmac_f32 v46, v24, v8
    v_fmac_f32 v47, v24, v9
    v_lshlrev_b32 v8, 16, v100
    v_and_b32 v9, 0xffff0000, v100
    v_fmac_f32 v40, v25, v8
    v_fmac_f32 v41, v25, v9
    v_lshlrev_b32 v8, 16, v101
    v_and_b32 v9, 0xffff0000, v101
    v_fmac_f32 v42, v25, v8
    v_fmac_f32 v43, v25, v9
    v_lshlrev_b32 v8, 16, v102
    v_and_b32 v9, 0xffff0000, v102
    v_fmac_f32 v44, v25, v8
    v_fmac_f32 v45, v25, v9
    v_lshlrev_b32 v8, 16, v103
    v_and_b32 v9, 0xffff0000, v103
    v_fmac_f32 v46, v25, v8
    v_fmac_f32 v47, v25, v9
    s_nop 1
    v_permlane32_swap_b32 v40, v44
    v_permlane32_swap_b32 v41, v45
    v_permlane32_swap_b32 v42, v46
    v_permlane32_swap_b32 v43, v47
    v_add_f32 v40, v40, v44
    v_add_f32 v41, v41, v45
    v_add_f32 v42, v42, v46
    v_add_f32 v43, v43, v47
    s_nop 1
    v_permlane16_swap_b32 v40, v42
    v_permlane16_swap_b32 v41, v43
    v_add_f32 v40, v40, v42
    v_add_f32 v41, v41, v43
    s_nop 1
    v_add_f32_dpp v40, v40, v40 row_ror:4 row_mask:0xf bank_mask:0xf
    v_add_f32_dpp v41, v41, v41 row_ror:4 row_mask:0xf bank_mask:0xf
    s_nop 1
    v_add_f32_dpp v40, v40, v40 row_ror:8 row_mask:0xf bank_mask:0xf
    v_add_f32_dpp v41, v41, v41 row_ror:8 row_mask:0xf bank_mask:0xf
    v_lshrrev_b32 v9, 4, v1
    v_and_b32 v8, 1, v9
    v_lshrrev_b32 v9, 1, v9
    v_lshlrev_b32 v8, 3, v8
    v_lshl_add_u32 v8, v9, 4, v8
    v_and_b32 v9, 3, v1
    v_lshl_add_u32 v8, v9, 5, v8
    s_mul_i32 s28, s27, 128
    s_add_u32 s28, s28, 161792
    v_add_u32 v8, s28, v8
    s_mov_b32 exec_lo, 0xf000f
    s_mov_b32 exec_hi, 0xf000f
    ds_write_b64 v8, v[40:41]
    s_mov_b64 exec, -1
    s_waitcnt lgkmcnt(0)
    v_mov_b32 v8, 162816
    v_mov_b32 v9, 1
    s_mov_b64 exec, 1
    ds_add_u32 v8, v9
    s_mov_b64 exec, -1
    s_cmp_lg_u32 s27, 0
    s_cbranch_scc1 .Lp1_done
    v_mov_b32 v8, 162816
.aw_3:
    ds_read_b32 v9, v8
    s_waitcnt lgkmcnt(0)
    v_readfirstlane_b32 s28, v9
    s_nop 0
    s_cmp_lt_u32 s28, 4
    s_cbranch_scc1 .aw_3
    v_add_u32 v8, 161792, v3
    ds_read_b32 v44, v8 offset:0
    ds_read_b32 v45, v8 offset:128
    ds_read_b32 v46, v8 offset:256
    ds_read_b32 v47, v8 offset:384
    s_waitcnt lgkmcnt(0)
    v_add_f32 v44, v44, v45
    v_add_f32 v46, v46, v47
    v_add_f32 v44, v44, v46
    v_cvt_pk_bf16_f32 v8, v44, v44
    v_lshlrev_b32 v44, 16, v8
    s_mov_b64 exec, 0xffffffff
    s_cmp_ge_u32 s2, 40
    s_cbranch_scc1 .Lp1_nc
    v_mov_b32 v45, s70
    v_lshlrev_b32 v8, 3, v1
    s_lshl_b32 s28, s2, 8
    s_add_u32 s28, s28, 49152
    buffer_store_dwordx2 v[44:45], v8, s[8:11], s28 offen sc0 sc1
    s_mov_b64 exec, -1
    s_branch .Lp1_done
.Lp1_nc:
    v_mov_b32 v8, 0x7fc00000
    v_cmp_eq_u32 vcc, -1, v44
    s_nop 1
    v_cndmask_b32 v44, v44, v8, vcc
    s_lshl_b32 s28, s2, 7
    buffer_store_dword v44, v3, s[8:11], s28 offen offset:0 sc0 sc1
    s_mov_b64 exec, -1
    s_branch .Lp1_done
.Lp1_q:
    s_waitcnt vmcnt(10)
    v_lshlrev_b32 v28, 16, v28
    v_lshlrev_b32 v16, 16, v16
    v_lshlrev_b32 v29, 16, v29
    v_lshlrev_b32 v17, 16, v17
    v_lshlrev_b32 v30, 16, v30
    v_lshlrev_b32 v18, 16, v18
    v_lshlrev_b32 v31, 16, v31
    v_lshlrev_b32 v19, 16, v19
    v_lshlrev_b32 v32, 16, v32
    v_lshlrev_b32 v20, 16, v20
    v_lshlrev_b32 v33, 16, v33
    v_lshlrev_b32 v21, 16, v21
    v_lshlrev_b32 v34, 16, v34
    v_lshlrev_b32 v22, 16, v22
    v_lshlrev_b32 v35, 16, v35
    v_lshlrev_b32 v23, 16, v23
    v_lshlrev_b32 v36, 16, v36
    v_lshlrev_b32 v24, 16, v24
    v_lshlrev_b32 v37, 16, v37
    v_lshlrev_b32 v25, 16, v25
    v_add_f32 v8, v28, v29
    v_add_f32 v8, v8, v30
    v_add_f32 v8, v8, v31
    v_add_f32 v8, v8, v32
    v_add_f32 v8, v8, v33
    v_add_f32 v8, v8, v34
    v_add_f32 v8, v8, v35
    v_add_f32 v8, v8, v36
    v_add_f32 v8, v8, v37
    s_nop 1
    v_add_f32_dpp v8, v8, v8 quad_perm:[1,0,3,2] row_mask:0xf bank_mask:0xf
    s_nop 1
    v_add_f32_dpp v8, v8, v8 quad_perm:[2,3,0,1] row_mask:0xf bank_mask:0xf
    s_nop 1
    v_add_f32_dpp v8, v8, v8 row_half_mirror row_mask:0xf bank_mask:0xf
    s_nop 1
    v_add_f32_dpp v8, v8, v8 row_mirror row_mask:0xf bank_mask:0xf
    s_nop 1
    v_readlane_b32 s40, v8, 0
    v_readlane_b32 s41, v8, 16
    v_readlane_b32 s42, v8, 32
    v_readlane_b32 s43, v8, 48
    s_nop 1
    v_mov_b32 v8, s40
    v_add_f32 v8, s41, v8
    v_add_f32 v8, s42, v8
    v_add_f32 v8, s43, v8
    v_mul_f32 v8, 0x3acccccd, v8
    v_sub_f32 v10, v28, v8
    v_mul_f32 v9, v10, v10
    v_sub_f32 v10, v29, v8
    v_fma_f32 v9, v10, v10, v9
    v_sub_f32 v10, v30, v8
    v_fma_f32 v9, v10, v10, v9
    v_sub_f32 v10, v31, v8
    v_fma_f32 v9, v10, v10, v9
    v_sub_f32 v10, v32, v8
    v_fma_f32 v9, v10, v10, v9
    v_sub_f32 v10, v33, v8
    v_fma_f32 v9, v10, v10, v9
    v_sub_f32 v10, v34, v8
    v_fma_f32 v9, v10, v10, v9
    v_sub_f32 v10, v35, v8
    v_fma_f32 v9, v10, v10, v9
    v_sub_f32 v10, v36, v8
    v_fma_f32 v9, v10, v10, v9
    v_sub_f32 v10, v37, v8
    v_fma_f32 v9, v10, v10, v9
    s_nop 1
    v_add_f32_dpp v9, v9, v9 quad_perm:[1,0,3,2] row_mask:0xf bank_mask:0xf
    s_nop 1
    v_add_f32_dpp v9, v9, v9 quad_perm:[2,3,0,1] row_mask:0xf bank_mask:0xf
    s_nop 1
    v_add_f32_dpp v9, v9, v9 row_half_mirror row_mask:0xf bank_mask:0xf
    s_nop 1
    v_add_f32_dpp v9, v9, v9 row_mirror row_mask:0xf bank_mask:0xf
    s_nop 1
    v_readlane_b32 s40, v9, 0
    v_readlane_b32 s41, v9, 16
    v_readlane_b32 s42, v9, 32
    v_readlane_b32 s43, v9, 48
    s_nop 1
    v_mov_b32 v9, s40
    v_add_f32 v9, s41, v9
    v_add_f32 v9, s42, v9
    v_add_f32 v9, s43, v9
    v_mul_f32 v9, 0x3acccccd, v9
    v_cvt_pk_bf16_f32 v10, v8, v8
    v_lshlrev_b32 v8, 16, v10
    v_cvt_pk_bf16_f32 v10, v9, v9
    v_lshlrev_b32 v9, 16, v10
    v_add_f32 v9, 0x3727c5ac, v9
    v_cvt_pk_bf16_f32 v10, v9, v9
    v_lshlrev_b32 v9, 16, v10
    v_sqrt_f32 v9, v9
    s_nop 0
    v_cvt_pk_bf16_f32 v10, v9, v9
    v_lshlrev_b32 v9, 16, v10
    v_sub_f32 v16, v16, v8
    v_cvt_pk_bf16_f32 v10, v16, v16
    v_lshlrev_b32 v16, 16, v10
    v_mov_b32 v11, v9
    v_rcp_f32 v12, v11
    s_nop 0
    v_mul_f32 v13, v16, v12
    v_fma_f32 v11, -v13, v11, v16
    v_fma_f32 v16, v11, v12, v13
    v_cvt_pk_bf16_f32 v10, v16, v16
    v_lshlrev_b32 v16, 16, v10
    v_sub_f32 v17, v17, v8
    v_cvt_pk_bf16_f32 v10, v17, v17
    v_lshlrev_b32 v17, 16, v10
    v_mov_b32 v11, v9
    v_rcp_f32 v12, v11
    s_nop 0
    v_mul_f32 v13, v17, v12
    v_fma_f32 v11, -v13, v11, v17
    v_fma_f32 v17, v11, v12, v13
    v_cvt_pk_bf16_f32 v10, v17, v17
    v_lshlrev_b32 v17, 16, v10
    v_sub_f32 v18, v18, v8
    v_cvt_pk_bf16_f32 v10, v18, v18
    v_lshlrev_b32 v18, 16, v10
    v_mov_b32 v11, v9
    v_rcp_f32 v12, v11
    s_nop 0
    v_mul_f32 v13, v18, v12
    v_fma_f32 v11, -v13, v11, v18
    v_fma_f32 v18, v11, v12, v13
    v_cvt_pk_bf16_f32 v10, v18, v18
    v_lshlrev_b32 v18, 16, v10
    v_sub_f32 v19, v19, v8
    v_cvt_pk_bf16_f32 v10, v19, v19
    v_lshlrev_b32 v19, 16, v10
    v_mov_b32 v11, v9
    v_rcp_f32 v12, v11
    s_nop 0
    v_mul_f32 v13, v19, v12
    v_fma_f32 v11, -v13, v11, v19
    v_fma_f32 v19, v11, v12, v13
    v_cvt_pk_bf16_f32 v10, v19, v19
    v_lshlrev_b32 v19, 16, v10
    v_sub_f32 v20, v20, v8
    v_cvt_pk_bf16_f32 v10, v20, v20
    v_lshlrev_b32 v20, 16, v10
    v_mov_b32 v11, v9
    v_rcp_f32 v12, v11
    s_nop 0
    v_mul_f32 v13, v20, v12
    v_fma_f32 v11, -v13, v11, v20
    v_fma_f32 v20, v11, v12, v13
    v_cvt_pk_bf16_f32 v10, v20, v20
    v_lshlrev_b32 v20, 16, v10
    v_sub_f32 v21, v21, v8
    v_cvt_pk_bf16_f32 v10, v21, v21
    v_lshlrev_b32 v21, 16, v10
    v_mov_b32 v11, v9
    v_rcp_f32 v12, v11
    s_nop 0
    v_mul_f32 v13, v21, v12
    v_fma_f32 v11, -v13, v11, v21
    v_fma_f32 v21, v11, v12, v13
    v_cvt_pk_bf16_f32 v10, v21, v21
    v_lshlrev_b32 v21, 16, v10
    v_sub_f32 v22, v22, v8
    v_cvt_pk_bf16_f32 v10, v22, v22
    v_lshlrev_b32 v22, 16, v10
    v_mov_b32 v11, v9
    v_rcp_f32 v12, v11
    s_nop 0
    v_mul_f32 v13, v22, v12
    v_fma_f32 v11, -v13, v11, v22
    v_fma_f32 v22, v11, v12, v13
    v_cvt_pk_bf16_f32 v10, v22, v22
    v_lshlrev_b32 v22, 16, v10
    v_sub_f32 v23, v23, v8
    v_cvt_pk_bf16_f32 v10, v23, v23
    v_lshlrev_b32 v23, 16, v10
    v_mov_b32 v11, v9
    v_rcp_f32 v12, v11
    s_nop 0
    v_mul_f32 v13, v23, v12
    v_fma_f32 v11, -v13, v11, v23
    v_fma_f32 v23, v11, v12, v13
    v_cvt_pk_bf16_f32 v10, v23, v23
    v_lshlrev_b32 v23, 16, v10
    v_sub_f32 v24, v24, v8
    v_cvt_pk_bf16_f32 v10, v24, v24
    v_lshlrev_b32 v24, 16, v10
    v_mov_b32 v11, v9
    v_rcp_f32 v12, v11
    s_nop 0
    v_mul_f32 v13, v24, v12
    v_fma_f32 v11, -v13, v11, v24
    v_fma_f32 v24, v11, v12, v13
    v_cvt_pk_bf16_f32 v10, v24, v24
    v_lshlrev_b32 v24, 16, v10
    v_sub_f32 v25, v25, v8
    v_cvt_pk_bf16_f32 v10, v25, v25
    v_lshlrev_b32 v25, 16, v10
    v_mov_b32 v11, v9
    v_rcp_f32 v12, v11
    s_nop 0
    v_mul_f32 v13, v25, v12
    v_fma_f32 v11, -v13, v11, v25
    v_fma_f32 v25, v11, v12, v13
    v_cvt_pk_bf16_f32 v10, v25, v25
    v_lshlrev_b32 v25, 16, v10
.Lp1_done:
    s_cmp_ge_u32 s2, 64
    s_cbranch_scc1 .Lp2_q
.Lp2_none:
    s_branch .Lp2_done
.Lp2_q:
    v_mov_b32 v12, 160516
    s_cmp_lg_u32 s27, 0
    s_cbranch_scc1 .Lm_wait
    v_lshlrev_b32 v13, 4, v1
    s_mov_b32 s29, 49152
    s_mov_b32 s39, 0
.pt_4:
    buffer_load_dwordx4 v[144:147], v13, s[8:11], s29 offen offset:0 sc1
    buffer_load_dwordx4 v[148:151], v13, s[8:11], s29 offen offset:1024 sc1
    buffer_load_dwordx4 v[152:155], v13, s[8:11], s29 offen offset:2048 sc1
    buffer_load_dwordx4 v[156:159], v13, s[8:11], s29 offen offset:3072 sc1
    s_mov_b32 s100, 53248
    buffer_load_dwordx4 v[160:163], v13, s[8:11], s100 offen sc1
    s_mov_b32 s100, 54272
    buffer_load_dwordx4 v[164:167], v13, s[8:11], s100 offen sc1
    s_mov_b32 s100, 55296
    buffer_load_dwordx4 v[168:171], v13, s[8:11], s100 offen sc1
    s_mov_b32 s100, 56320
    buffer_load_dwordx4 v[172:175], v13, s[8:11], s100 offen sc1
    s_mov_b32 s100, 57344
    buffer_load_dwordx4 v[176:179], v13, s[8:11], s100 offen sc1
    s_mov_b32 s100, 58368
    buffer_load_dwordx4 v[180:183], v13, s[8:11], s100 offen sc1
    s_waitcnt vmcnt(0)
    v_xor_b32 v53, s70, v145
    v_xor_b32 v54, s70, v147
    v_or_b32 v53, v53, v54
    v_xor_b32 v54, s70, v149
    v_or_b32 v53, v53, v54
    v_xor_b32 v54, s70, v151
    v_or_b32 v53, v53, v54
    v_xor_b32 v54, s70, v153
    v_or_b32 v53, v53, v54
    v_xor_b32 v54, s70, v155
    v_or_b32 v53, v53, v54
    v_xor_b32 v54, s70, v157
    v_or_b32 v53, v53, v54
    v_xor_b32 v54, s70, v159
    v_or_b32 v53, v53, v54
    v_xor_b32 v54, s70, v161
    v_or_b32 v53, v53, v54
    v_xor_b32 v54, s70, v163
    v_or_b32 v53, v53, v54
    v_xor_b32 v54, s70, v165
    v_or_b32 v53, v53, v54
    v_xor_b32 v54, s70, v167
    v_or_b32 v53, v53, v54
    v_xor_b32 v54, s70, v169
    v_or_b32 v53, v53, v54
    v_xor_b32 v54, s70, v171
    v_or_b32 v53, v53, v54
    v_xor_b32 v54, s70, v173
    v_or_b32 v53, v53, v54
    v_xor_b32 v54, s70, v175
    v_or_b32 v53, v53, v54
    v_xor_b32 v54, s70, v177
    v_or_b32 v53, v53, v54
    v_xor_b32 v54, s70, v179
    v_or_b32 v53, v53, v54
    v_xor_b32 v54, s70, v181
    v_or_b32 v53, v53, v54
    v_xor_b32 v54, s70, v183
    v_or_b32 v53, v53, v54
    v_cmp_ne_u32 vcc, 0, v53
    s_cbranch_vccz .ptd_5
    s_add_u32 s39, s39, 1
    s_cmp_gt_u32 s39, 400000
    s_cbranch_scc1 .ptd_5
    s_sleep 2
    s_branch .pt_4
.ptd_5:
    v_lshlrev_b32 v13, 3, v1
    v_add_u32 v13, 154624, v13
    v_mov_b32 v145, v146
    ds_write_b64 v13, v[144:145] offset:0
    v_mov_b32 v149, v150
    ds_write_b64 v13, v[148:149] offset:512
    v_mov_b32 v153, v154
    ds_write_b64 v13, v[152:153] offset:1024
    v_mov_b32 v157, v158
    ds_write_b64 v13, v[156:157] offset:1536
    v_mov_b32 v161, v162
    ds_write_b64 v13, v[160:161] offset:2048
    v_mov_b32 v165, v166
    ds_write_b64 v13, v[164:165] offset:2560
    v_mov_b32 v169, v170
    ds_write_b64 v13, v[168:169] offset:3072
    v_mov_b32 v173, v174
    ds_write_b64 v13, v[172:173] offset:3584
    v_mov_b32 v177, v178
    ds_write_b64 v13, v[176:177] offset:4096
    v_mov_b32 v181, v182
    ds_write_b64 v13, v[180:181] offset:4608
    s_waitcnt lgkmcnt(0)
    v_mov_b32 v13, 1
    ds_write_b32 v12, v13
.Lm_wait:
    ds_read_b32 v13, v12
    s_waitcnt lgkmcnt(0)
    v_readfirstlane_b32 s28, v13
    s_nop 0
    s_cmp_eq_u32 s28, 1
    s_cbranch_scc1 .Lm_ok
    s_sleep 1
    s_branch .Lm_wait
.Lm_ok:
    v_add_u32 v13, 154624, v14
    ds_read_b32 v144, v13 offset:0
    ds_read_b32 v154, v13 offset:2560
    ds_read_b32 v145, v13 offset:64
    ds_read_b32 v155, v13 offset:2624
    ds_read_b32 v146, v13 offset:128
    ds_read_b32 v156, v13 offset:2688
    ds_read_b32 v147, v13 offset:192
    ds_read_b32 v157, v13 offset:2752
    ds_read_b32 v148, v13 offset:256
    ds_read_b32 v158, v13 offset:2816
    ds_read_b32 v149, v13 offset:320
    ds_read_b32 v159, v13 offset:2880
    ds_read_b32 v150, v13 offset:384
    ds_read_b32 v160, v13 offset:2944
    ds_read_b32 v151, v13 offset:448
    ds_read_b32 v161, v13 offset:3008
    ds_read_b32 v152, v13 offset:512
    ds_read_b32 v162, v13 offset:3072
    ds_read_b32 v153, v13 offset:576
    ds_read_b32 v163, v13 offset:3136
    s_waitcnt vmcnt(0) lgkmcnt(0)
    v_add_f32 v154, 1.0, v154
    v_cvt_pk_bf16_f32 v10, v154, v154
    v_lshlrev_b32 v154, 16, v10
    v_mul_f32 v16, v16, v154
    v_cvt_pk_bf16_f32 v10, v16, v16
    v_lshlrev_b32 v16, 16, v10
    v_add_f32 v16, v16, v144
    v_cvt_pk_bf16_f32 v10, v16, v16
    v_lshlrev_b32 v16, 16, v10
    v_add_f32 v155, 1.0, v155
    v_cvt_pk_bf16_f32 v10, v155, v155
    v_lshlrev_b32 v155, 16, v10
    v_mul_f32 v17, v17, v155
    v_cvt_pk_bf16_f32 v10, v17, v17
    v_lshlrev_b32 v17, 16, v10
    v_add_f32 v17, v17, v145
    v_cvt_pk_bf16_f32 v10, v17, v17
    v_lshlrev_b32 v17, 16, v10
    v_add_f32 v156, 1.0, v156
    v_cvt_pk_bf16_f32 v10, v156, v156
    v_lshlrev_b32 v156, 16, v10
    v_mul_f32 v18, v18, v156
    v_cvt_pk_bf16_f32 v10, v18, v18
    v_lshlrev_b32 v18, 16, v10
    v_add_f32 v18, v18, v146
    v_cvt_pk_bf16_f32 v10, v18, v18
    v_lshlrev_b32 v18, 16, v10
    v_add_f32 v157, 1.0, v157
    v_cvt_pk_bf16_f32 v10, v157, v157
    v_lshlrev_b32 v157, 16, v10
    v_mul_f32 v19, v19, v157
    v_cvt_pk_bf16_f32 v10, v19, v19
    v_lshlrev_b32 v19, 16, v10
    v_add_f32 v19, v19, v147
    v_cvt_pk_bf16_f32 v10, v19, v19
    v_lshlrev_b32 v19, 16, v10
    v_add_f32 v158, 1.0, v158
    v_cvt_pk_bf16_f32 v10, v158, v158
    v_lshlrev_b32 v158, 16, v10
    v_mul_f32 v20, v20, v158
    v_cvt_pk_bf16_f32 v10, v20, v20
    v_lshlrev_b32 v20, 16, v10
    v_add_f32 v20, v20, v148
    v_cvt_pk_bf16_f32 v10, v20, v20
    v_lshlrev_b32 v20, 16, v10
    v_add_f32 v159, 1.0, v159
    v_cvt_pk_bf16_f32 v10, v159, v159
    v_lshlrev_b32 v159, 16, v10
    v_mul_f32 v21, v21, v159
    v_cvt_pk_bf16_f32 v10, v21, v21
    v_lshlrev_b32 v21, 16, v10
    v_add_f32 v21, v21, v149
    v_cvt_pk_bf16_f32 v10, v21, v21
    v_lshlrev_b32 v21, 16, v10
    v_add_f32 v160, 1.0, v160
    v_cvt_pk_bf16_f32 v10, v160, v160
    v_lshlrev_b32 v160, 16, v10
    v_mul_f32 v22, v22, v160
    v_cvt_pk_bf16_f32 v10, v22, v22
    v_lshlrev_b32 v22, 16, v10
    v_add_f32 v22, v22, v150
    v_cvt_pk_bf16_f32 v10, v22, v22
    v_lshlrev_b32 v22, 16, v10
    v_add_f32 v161, 1.0, v161
    v_cvt_pk_bf16_f32 v10, v161, v161
    v_lshlrev_b32 v161, 16, v10
    v_mul_f32 v23, v23, v161
    v_cvt_pk_bf16_f32 v10, v23, v23
    v_lshlrev_b32 v23, 16, v10
    v_add_f32 v23, v23, v151
    v_cvt_pk_bf16_f32 v10, v23, v23
    v_lshlrev_b32 v23, 16, v10
    v_add_f32 v162, 1.0, v162
    v_cvt_pk_bf16_f32 v10, v162, v162
    v_lshlrev_b32 v162, 16, v10
    v_mul_f32 v24, v24, v162
    v_cvt_pk_bf16_f32 v10, v24, v24
    v_lshlrev_b32 v24, 16, v10
    v_add_f32 v24, v24, v152
    v_cvt_pk_bf16_f32 v10, v24, v24
    v_lshlrev_b32 v24, 16, v10
    v_add_f32 v163, 1.0, v163
    v_cvt_pk_bf16_f32 v10, v163, v163
    v_lshlrev_b32 v163, 16, v10
    v_mul_f32 v25, v25, v163
    v_cvt_pk_bf16_f32 v10, v25, v25
    v_lshlrev_b32 v25, 16, v10
    v_add_f32 v25, v25, v153
    v_cvt_pk_bf16_f32 v10, v25, v25
    v_lshlrev_b32 v25, 16, v10
    v_lshlrev_b32 v8, 16, v104
    v_and_b32 v9, 0xffff0000, v104
    v_mul_f32 v40, v16, v8
    v_mul_f32 v41, v16, v9
    v_lshlrev_b32 v8, 16, v105
    v_and_b32 v9, 0xffff0000, v105
    v_mul_f32 v42, v16, v8
    v_mul_f32 v43, v16, v9
    v_lshlrev_b32 v8, 16, v106
    v_and_b32 v9, 0xffff0000, v106
    v_mul_f32 v44, v16, v8
    v_mul_f32 v45, v16, v9
    v_lshlrev_b32 v8, 16, v107
    v_and_b32 v9, 0xffff0000, v107
    v_mul_f32 v46, v16, v8
    v_mul_f32 v47, v16, v9
    v_lshlrev_b32 v8, 16, v108
    v_and_b32 v9, 0xffff0000, v108
    v_fmac_f32 v40, v17, v8
    v_fmac_f32 v41, v17, v9
    v_lshlrev_b32 v8, 16, v109
    v_and_b32 v9, 0xffff0000, v109
    v_fmac_f32 v42, v17, v8
    v_fmac_f32 v43, v17, v9
    v_lshlrev_b32 v8, 16, v110
    v_and_b32 v9, 0xffff0000, v110
    v_fmac_f32 v44, v17, v8
    v_fmac_f32 v45, v17, v9
    v_lshlrev_b32 v8, 16, v111
    v_and_b32 v9, 0xffff0000, v111
    v_fmac_f32 v46, v17, v8
    v_fmac_f32 v47, v17, v9
    v_lshlrev_b32 v8, 16, v112
    v_and_b32 v9, 0xffff0000, v112
    v_fmac_f32 v40, v18, v8
    v_fmac_f32 v41, v18, v9
    v_lshlrev_b32 v8, 16, v113
    v_and_b32 v9, 0xffff0000, v113
    v_fmac_f32 v42, v18, v8
    v_fmac_f32 v43, v18, v9
    v_lshlrev_b32 v8, 16, v114
    v_and_b32 v9, 0xffff0000, v114
    v_fmac_f32 v44, v18, v8
    v_fmac_f32 v45, v18, v9
    v_lshlrev_b32 v8, 16, v115
    v_and_b32 v9, 0xffff0000, v115
    v_fmac_f32 v46, v18, v8
    v_fmac_f32 v47, v18, v9
    v_lshlrev_b32 v8, 16, v116
    v_and_b32 v9, 0xffff0000, v116
    v_fmac_f32 v40, v19, v8
    v_fmac_f32 v41, v19, v9
    v_lshlrev_b32 v8, 16, v117
    v_and_b32 v9, 0xffff0000, v117
    v_fmac_f32 v42, v19, v8
    v_fmac_f32 v43, v19, v9
    v_lshlrev_b32 v8, 16, v118
    v_and_b32 v9, 0xffff0000, v118
    v_fmac_f32 v44, v19, v8
    v_fmac_f32 v45, v19, v9
    v_lshlrev_b32 v8, 16, v119
    v_and_b32 v9, 0xffff0000, v119
    v_fmac_f32 v46, v19, v8
    v_fmac_f32 v47, v19, v9
    v_lshlrev_b32 v8, 16, v120
    v_and_b32 v9, 0xffff0000, v120
    v_fmac_f32 v40, v20, v8
    v_fmac_f32 v41, v20, v9
    v_lshlrev_b32 v8, 16, v121
    v_and_b32 v9, 0xffff0000, v121
    v_fmac_f32 v42, v20, v8
    v_fmac_f32 v43, v20, v9
    v_lshlrev_b32 v8, 16, v122
    v_and_b32 v9, 0xffff0000, v122
    v_fmac_f32 v44, v20, v8
    v_fmac_f32 v45, v20, v9
    v_lshlrev_b32 v8, 16, v123
    v_and_b32 v9, 0xffff0000, v123
    v_fmac_f32 v46, v20, v8
    v_fmac_f32 v47, v20, v9
    v_lshlrev_b32 v8, 16, v124
    v_and_b32 v9, 0xffff0000, v124
    v_fmac_f32 v40, v21, v8
    v_fmac_f32 v41, v21, v9
    v_lshlrev_b32 v8, 16, v125
    v_and_b32 v9, 0xffff0000, v125
    v_fmac_f32 v42, v21, v8
    v_fmac_f32 v43, v21, v9
    v_lshlrev_b32 v8, 16, v126
    v_and_b32 v9, 0xffff0000, v126
    v_fmac_f32 v44, v21, v8
    v_fmac_f32 v45, v21, v9
    v_lshlrev_b32 v8, 16, v127
    v_and_b32 v9, 0xffff0000, v127
    v_fmac_f32 v46, v21, v8
    v_fmac_f32 v47, v21, v9
    v_lshlrev_b32 v8, 16, v128
    v_and_b32 v9, 0xffff0000, v128
    v_fmac_f32 v40, v22, v8
    v_fmac_f32 v41, v22, v9
    v_lshlrev_b32 v8, 16, v129
    v_and_b32 v9, 0xffff0000, v129
    v_fmac_f32 v42, v22, v8
    v_fmac_f32 v43, v22, v9
    v_lshlrev_b32 v8, 16, v130
    v_and_b32 v9, 0xffff0000, v130
    v_fmac_f32 v44, v22, v8
    v_fmac_f32 v45, v22, v9
    v_lshlrev_b32 v8, 16, v131
    v_and_b32 v9, 0xffff0000, v131
    v_fmac_f32 v46, v22, v8
    v_fmac_f32 v47, v22, v9
    v_lshlrev_b32 v8, 16, v132
    v_and_b32 v9, 0xffff0000, v132
    v_fmac_f32 v40, v23, v8
    v_fmac_f32 v41, v23, v9
    v_lshlrev_b32 v8, 16, v133
    v_and_b32 v9, 0xffff0000, v133
    v_fmac_f32 v42, v23, v8
    v_fmac_f32 v43, v23, v9
    v_lshlrev_b32 v8, 16, v134
    v_and_b32 v9, 0xffff0000, v134
    v_fmac_f32 v44, v23, v8
    v_fmac_f32 v45, v23, v9
    v_lshlrev_b32 v8, 16, v135
    v_and_b32 v9, 0xffff0000, v135
    v_fmac_f32 v46, v23, v8
    v_fmac_f32 v47, v23, v9
    v_lshlrev_b32 v8, 16, v136
    v_and_b32 v9, 0xffff0000, v136
    v_fmac_f32 v40, v24, v8
    v_fmac_f32 v41, v24, v9
    v_lshlrev_b32 v8, 16, v137
    v_and_b32 v9, 0xffff0000, v137
    v_fmac_f32 v42, v24, v8
    v_fmac_f32 v43, v24, v9
    v_lshlrev_b32 v8, 16, v138
    v_and_b32 v9, 0xffff0000, v138
    v_fmac_f32 v44, v24, v8
    v_fmac_f32 v45, v24, v9
    v_lshlrev_b32 v8, 16, v139
    v_and_b32 v9, 0xffff0000, v139
    v_fmac_f32 v46, v24, v8
    v_fmac_f32 v47, v24, v9
    v_lshlrev_b32 v8, 16, v140
    v_and_b32 v9, 0xffff0000, v140
    v_fmac_f32 v40, v25, v8
    v_fmac_f32 v41, v25, v9
    v_lshlrev_b32 v8, 16, v141
    v_and_b32 v9, 0xffff0000, v141
    v_fmac_f32 v42, v25, v8
    v_fmac_f32 v43, v25, v9
    v_lshlrev_b32 v8, 16, v142
    v_and_b32 v9, 0xffff0000, v142
    v_fmac_f32 v44, v25, v8
    v_fmac_f32 v45, v25, v9
    v_lshlrev_b32 v8, 16, v143
    v_and_b32 v9, 0xffff0000, v143
    v_fmac_f32 v46, v25, v8
    v_fmac_f32 v47, v25, v9
    s_nop 1
    v_permlane32_swap_b32 v40, v44
    v_permlane32_swap_b32 v41, v45
    v_permlane32_swap_b32 v42, v46
    v_permlane32_swap_b32 v43, v47
    v_add_f32 v40, v40, v44
    v_add_f32 v41, v41, v45
    v_add_f32 v42, v42, v46
    v_add_f32 v43, v43, v47
    s_nop 1
    v_permlane16_swap_b32 v40, v42
    v_permlane16_swap_b32 v41, v43
    v_add_f32 v40, v40, v42
    v_add_f32 v41, v41, v43
    s_nop 1
    v_add_f32_dpp v40, v40, v40 row_ror:4 row_mask:0xf bank_mask:0xf
    v_add_f32_dpp v41, v41, v41 row_ror:4 row_mask:0xf bank_mask:0xf
    s_nop 1
    v_add_f32_dpp v40, v40, v40 row_ror:8 row_mask:0xf bank_mask:0xf
    v_add_f32_dpp v41, v41, v41 row_ror:8 row_mask:0xf bank_mask:0xf
    v_lshrrev_b32 v9, 4, v1
    v_and_b32 v8, 1, v9
    v_lshrrev_b32 v9, 1, v9
    v_lshlrev_b32 v8, 3, v8
    v_lshl_add_u32 v8, v9, 4, v8
    v_and_b32 v9, 3, v1
    v_lshl_add_u32 v8, v9, 5, v8
    s_mul_i32 s28, s27, 128
    s_add_u32 s28, s28, 162304
    v_add_u32 v8, s28, v8
    s_mov_b32 exec_lo, 0xf000f
    s_mov_b32 exec_hi, 0xf000f
    ds_write_b64 v8, v[40:41]
    s_mov_b64 exec, -1
    s_waitcnt lgkmcnt(0)
    v_mov_b32 v8, 162820
    v_mov_b32 v9, 1
    s_mov_b64 exec, 1
    ds_add_u32 v8, v9
    s_mov_b64 exec, -1
    s_cmp_lg_u32 s27, 0
    s_cbranch_scc1 .Lp2_done
    v_mov_b32 v8, 162820
.aw_6:
    ds_read_b32 v9, v8
    s_waitcnt lgkmcnt(0)
    v_readfirstlane_b32 s28, v9
    s_nop 0
    s_cmp_lt_u32 s28, 4
    s_cbranch_scc1 .aw_6
    v_add_u32 v8, 162304, v3
    ds_read_b32 v44, v8 offset:0
    ds_read_b32 v45, v8 offset:128
    ds_read_b32 v46, v8 offset:256
    ds_read_b32 v47, v8 offset:384
    s_waitcnt lgkmcnt(0)
    v_add_f32 v44, v44, v45
    v_add_f32 v46, v46, v47
    v_add_f32 v44, v44, v46
    s_nop 1
    v_mov_b32_dpp v45, v44 quad_perm:[1,0,3,2] row_mask:0xf bank_mask:0xf
    v_cvt_pk_bf16_f32 v44, v44, v45
    v_mov_b32 v45, s70
    s_sub_u32 s28, s2, 64
    s_lshl_b32 s28, s28, 7
    s_add_u32 s28, s28, 524288
    s_mov_b32 exec_lo, 0x55555555
    s_mov_b32 exec_hi, 0
    buffer_store_dwordx2 v[44:45], v3, s[8:11], s28 offen sc0 sc1
    s_mov_b64 exec, -1
.Lp2_done:
    s_setprio 0
    s_cmp_lg_u32 s27, 0
    s_cbranch_scc1 .Lnobias
    s_xor_b32 s28, s2, 1
    s_lshl_b32 s28, s28, 3
    s_add_u32 s29, s28, 61440
    s_mov_b32 s39, 0
.pt_7:
    buffer_load_dwordx2 v[10:11], v52, s[8:11], s29 offen sc1
    s_waitcnt vmcnt(0)
    v_xor_b32 v12, s70, v11
    v_cmp_ne_u32 vcc, 0, v12
    s_cbranch_vccz .ptd_8
    s_add_u32 s39, s39, 1
    s_cmp_gt_u32 s39, 400000
    s_cbranch_scc1 .ptd_8
    s_sleep 2
    s_branch .pt_7
.ptd_8:
    v_readfirstlane_b32 s28, v10
    s_nop 0
    s_and_b32 s29, s2, 1
    s_cmp_eq_u32 s29, 0
    s_cselect_b32 s30, s28, s69
    s_cselect_b32 s31, s69, s28
    s_sub_u32 s30, s30, s31
    v_mov_b32 v10, s30
    v_mov_b32 v11, 162844
    ds_write_b32 v11, v10
.Lnobias:
    s_sub_u32 s28, s2, 64
    s_cmp_ge_u32 s28, 56
    s_cbranch_scc1 .Lp3_done
    buffer_load_ushort v16, v7, s[48:51], 0 offen offset:0
    buffer_load_ushort v17, v7, s[48:51], 0 offen offset:32
    buffer_load_ushort v18, v7, s[48:51], 0 offen offset:64
    buffer_load_ushort v19, v7, s[48:51], 0 offen offset:96
    buffer_load_ushort v20, v7, s[48:51], 0 offen offset:128
    buffer_load_ushort v21, v7, s[48:51], 0 offen offset:160
    buffer_load_ushort v22, v7, s[48:51], 0 offen offset:192
    buffer_load_ushort v23, v7, s[48:51], 0 offen offset:224
    buffer_load_ushort v24, v7, s[48:51], 0 offen offset:256
    buffer_load_ushort v25, v7, s[48:51], 0 offen offset:288
    v_mul_u32_u24 v8, 7680, v6
    v_lshl_add_u32 v8, v5, 4, v8
    s_lshl_b32 s28, s2, 6
    buffer_load_dwordx4 v[64:67], v8, s[52:55], s28 offen
    s_add_u32 s28, s28, 122880
    buffer_load_dwordx4 v[68:71], v8, s[52:55], s28 offen
    s_add_u32 s28, s28, 122880
    buffer_load_dwordx4 v[72:75], v8, s[52:55], s28 offen
    s_add_u32 s28, s28, 122880
    buffer_load_dwordx4 v[76:79], v8, s[52:55], s28 offen
    s_add_u32 s28, s28, 122880
    buffer_load_dwordx4 v[80:83], v8, s[52:55], s28 offen
    s_add_u32 s28, s28, 122880
    buffer_load_dwordx4 v[84:87], v8, s[52:55], s28 offen
    s_add_u32 s28, s28, 122880
    buffer_load_dwordx4 v[88:91], v8, s[52:55], s28 offen
    s_add_u32 s28, s28, 122880
    buffer_load_dwordx4 v[92:95], v8, s[52:55], s28 offen
    s_add_u32 s28, s28, 122880
    buffer_load_dwordx4 v[96:99], v8, s[52:55], s28 offen
    s_add_u32 s28, s28, 122880
    buffer_load_dwordx4 v[100:103], v8, s[52:55], s28 offen
    s_add_u32 s28, s28, 122880
    s_waitcnt vmcnt(10)
    v_lshlrev_b32 v16, 16, v16
    v_mov_b32 v11, 0x200
    v_mul_f32 v8, 0xbfb8aa3b, v16
    v_exp_f32 v8, v8
    s_nop 0
    v_add_f32 v8, 1.0, v8
    v_cmp_class_f32 vcc, v8, v11
    v_rcp_f32 v9, v8
    s_nop 0
    v_mul_f32 v10, v16, v9
    v_fma_f32 v8, -v10, v8, v16
    v_fma_f32 v16, v8, v9, v10
    v_cndmask_b32 v16, v16, v10, vcc
    v_cvt_pk_bf16_f32 v8, v16, v16
    v_lshlrev_b32 v16, 16, v8
    v_lshlrev_b32 v17, 16, v17
    v_mov_b32 v11, 0x200
    v_mul_f32 v8, 0xbfb8aa3b, v17
    v_exp_f32 v8, v8
    s_nop 0
    v_add_f32 v8, 1.0, v8
    v_cmp_class_f32 vcc, v8, v11
    v_rcp_f32 v9, v8
    s_nop 0
    v_mul_f32 v10, v17, v9
    v_fma_f32 v8, -v10, v8, v17
    v_fma_f32 v17, v8, v9, v10
    v_cndmask_b32 v17, v17, v10, vcc
    v_cvt_pk_bf16_f32 v8, v17, v17
    v_lshlrev_b32 v17, 16, v8
    v_lshlrev_b32 v18, 16, v18
    v_mov_b32 v11, 0x200
    v_mul_f32 v8, 0xbfb8aa3b, v18
    v_exp_f32 v8, v8
    s_nop 0
    v_add_f32 v8, 1.0, v8
    v_cmp_class_f32 vcc, v8, v11
    v_rcp_f32 v9, v8
    s_nop 0
    v_mul_f32 v10, v18, v9
    v_fma_f32 v8, -v10, v8, v18
    v_fma_f32 v18, v8, v9, v10
    v_cndmask_b32 v18, v18, v10, vcc
    v_cvt_pk_bf16_f32 v8, v18, v18
    v_lshlrev_b32 v18, 16, v8
    v_lshlrev_b32 v19, 16, v19
    v_mov_b32 v11, 0x200
    v_mul_f32 v8, 0xbfb8aa3b, v19
    v_exp_f32 v8, v8
    s_nop 0
    v_add_f32 v8, 1.0, v8
    v_cmp_class_f32 vcc, v8, v11
    v_rcp_f32 v9, v8
    s_nop 0
    v_mul_f32 v10, v19, v9
    v_fma_f32 v8, -v10, v8, v19
    v_fma_f32 v19, v8, v9, v10
    v_cndmask_b32 v19, v19, v10, vcc
    v_cvt_pk_bf16_f32 v8, v19, v19
    v_lshlrev_b32 v19, 16, v8
    v_lshlrev_b32 v20, 16, v20
    v_mov_b32 v11, 0x200
    v_mul_f32 v8, 0xbfb8aa3b, v20
    v_exp_f32 v8, v8
    s_nop 0
    v_add_f32 v8, 1.0, v8
    v_cmp_class_f32 vcc, v8, v11
    v_rcp_f32 v9, v8
    s_nop 0
    v_mul_f32 v10, v20, v9
    v_fma_f32 v8, -v10, v8, v20
    v_fma_f32 v20, v8, v9, v10
    v_cndmask_b32 v20, v20, v10, vcc
    v_cvt_pk_bf16_f32 v8, v20, v20
    v_lshlrev_b32 v20, 16, v8
    v_lshlrev_b32 v21, 16, v21
    v_mov_b32 v11, 0x200
    v_mul_f32 v8, 0xbfb8aa3b, v21
    v_exp_f32 v8, v8
    s_nop 0
    v_add_f32 v8, 1.0, v8
    v_cmp_class_f32 vcc, v8, v11
    v_rcp_f32 v9, v8
    s_nop 0
    v_mul_f32 v10, v21, v9
    v_fma_f32 v8, -v10, v8, v21
    v_fma_f32 v21, v8, v9, v10
    v_cndmask_b32 v21, v21, v10, vcc
    v_cvt_pk_bf16_f32 v8, v21, v21
    v_lshlrev_b32 v21, 16, v8
    v_lshlrev_b32 v22, 16, v22
    v_mov_b32 v11, 0x200
    v_mul_f32 v8, 0xbfb8aa3b, v22
    v_exp_f32 v8, v8
    s_nop 0
    v_add_f32 v8, 1.0, v8
    v_cmp_class_f32 vcc, v8, v11
    v_rcp_f32 v9, v8
    s_nop 0
    v_mul_f32 v10, v22, v9
    v_fma_f32 v8, -v10, v8, v22
    v_fma_f32 v22, v8, v9, v10
    v_cndmask_b32 v22, v22, v10, vcc
    v_cvt_pk_bf16_f32 v8, v22, v22
    v_lshlrev_b32 v22, 16, v8
    v_lshlrev_b32 v23, 16, v23
    v_mov_b32 v11, 0x200
    v_mul_f32 v8, 0xbfb8aa3b, v23
    v_exp_f32 v8, v8
    s_nop 0
    v_add_f32 v8, 1.0, v8
    v_cmp_class_f32 vcc, v8, v11
    v_rcp_f32 v9, v8
    s_nop 0
    v_mul_f32 v10, v23, v9
    v_fma_f32 v8, -v10, v8, v23
    v_fma_f32 v23, v8, v9, v10
    v_cndmask_b32 v23, v23, v10, vcc
    v_cvt_pk_bf16_f32 v8, v23, v23
    v_lshlrev_b32 v23, 16, v8
    v_lshlrev_b32 v24, 16, v24
    v_mov_b32 v11, 0x200
    v_mul_f32 v8, 0xbfb8aa3b, v24
    v_exp_f32 v8, v8
    s_nop 0
    v_add_f32 v8, 1.0, v8
    v_cmp_class_f32 vcc, v8, v11
    v_rcp_f32 v9, v8
    s_nop 0
    v_mul_f32 v10, v24, v9
    v_fma_f32 v8, -v10, v8, v24
    v_fma_f32 v24, v8, v9, v10
    v_cndmask_b32 v24, v24, v10, vcc
    v_cvt_pk_bf16_f32 v8, v24, v24
    v_lshlrev_b32 v24, 16, v8
    v_lshlrev_b32 v25, 16, v25
    v_mov_b32 v11, 0x200
    v_mul_f32 v8, 0xbfb8aa3b, v25
    v_exp_f32 v8, v8
    s_nop 0
    v_add_f32 v8, 1.0, v8
    v_cmp_class_f32 vcc, v8, v11
    v_rcp_f32 v9, v8
    s_nop 0
    v_mul_f32 v10, v25, v9
    v_fma_f32 v8, -v10, v8, v25
    v_fma_f32 v25, v8, v9, v10
    v_cndmask_b32 v25, v25, v10, vcc
    v_cvt_pk_bf16_f32 v8, v25, v25
    v_lshlrev_b32 v25, 16, v8
    s_waitcnt vmcnt(0)
    v_lshlrev_b32 v8, 16, v64
    v_and_b32 v9, 0xffff0000, v64
    v_mul_f32 v40, v16, v8
    v_mul_f32 v41, v16, v9
    v_lshlrev_b32 v8, 16, v65
    v_and_b32 v9, 0xffff0000, v65
    v_mul_f32 v42, v16, v8
    v_mul_f32 v43, v16, v9
    v_lshlrev_b32 v8, 16, v66
    v_and_b32 v9, 0xffff0000, v66
    v_mul_f32 v44, v16, v8
    v_mul_f32 v45, v16, v9
    v_lshlrev_b32 v8, 16, v67
    v_and_b32 v9, 0xffff0000, v67
    v_mul_f32 v46, v16, v8
    v_mul_f32 v47, v16, v9
    v_lshlrev_b32 v8, 16, v68
    v_and_b32 v9, 0xffff0000, v68
    v_fmac_f32 v40, v17, v8
    v_fmac_f32 v41, v17, v9
    v_lshlrev_b32 v8, 16, v69
    v_and_b32 v9, 0xffff0000, v69
    v_fmac_f32 v42, v17, v8
    v_fmac_f32 v43, v17, v9
    v_lshlrev_b32 v8, 16, v70
    v_and_b32 v9, 0xffff0000, v70
    v_fmac_f32 v44, v17, v8
    v_fmac_f32 v45, v17, v9
    v_lshlrev_b32 v8, 16, v71
    v_and_b32 v9, 0xffff0000, v71
    v_fmac_f32 v46, v17, v8
    v_fmac_f32 v47, v17, v9
    v_lshlrev_b32 v8, 16, v72
    v_and_b32 v9, 0xffff0000, v72
    v_fmac_f32 v40, v18, v8
    v_fmac_f32 v41, v18, v9
    v_lshlrev_b32 v8, 16, v73
    v_and_b32 v9, 0xffff0000, v73
    v_fmac_f32 v42, v18, v8
    v_fmac_f32 v43, v18, v9
    v_lshlrev_b32 v8, 16, v74
    v_and_b32 v9, 0xffff0000, v74
    v_fmac_f32 v44, v18, v8
    v_fmac_f32 v45, v18, v9
    v_lshlrev_b32 v8, 16, v75
    v_and_b32 v9, 0xffff0000, v75
    v_fmac_f32 v46, v18, v8
    v_fmac_f32 v47, v18, v9
    v_lshlrev_b32 v8, 16, v76
    v_and_b32 v9, 0xffff0000, v76
    v_fmac_f32 v40, v19, v8
    v_fmac_f32 v41, v19, v9
    v_lshlrev_b32 v8, 16, v77
    v_and_b32 v9, 0xffff0000, v77
    v_fmac_f32 v42, v19, v8
    v_fmac_f32 v43, v19, v9
    v_lshlrev_b32 v8, 16, v78
    v_and_b32 v9, 0xffff0000, v78
    v_fmac_f32 v44, v19, v8
    v_fmac_f32 v45, v19, v9
    v_lshlrev_b32 v8, 16, v79
    v_and_b32 v9, 0xffff0000, v79
    v_fmac_f32 v46, v19, v8
    v_fmac_f32 v47, v19, v9
    v_lshlrev_b32 v8, 16, v80
    v_and_b32 v9, 0xffff0000, v80
    v_fmac_f32 v40, v20, v8
    v_fmac_f32 v41, v20, v9
    v_lshlrev_b32 v8, 16, v81
    v_and_b32 v9, 0xffff0000, v81
    v_fmac_f32 v42, v20, v8
    v_fmac_f32 v43, v20, v9
    v_lshlrev_b32 v8, 16, v82
    v_and_b32 v9, 0xffff0000, v82
    v_fmac_f32 v44, v20, v8
    v_fmac_f32 v45, v20, v9
    v_lshlrev_b32 v8, 16, v83
    v_and_b32 v9, 0xffff0000, v83
    v_fmac_f32 v46, v20, v8
    v_fmac_f32 v47, v20, v9
    v_lshlrev_b32 v8, 16, v84
    v_and_b32 v9, 0xffff0000, v84
    v_fmac_f32 v40, v21, v8
    v_fmac_f32 v41, v21, v9
    v_lshlrev_b32 v8, 16, v85
    v_and_b32 v9, 0xffff0000, v85
    v_fmac_f32 v42, v21, v8
    v_fmac_f32 v43, v21, v9
    v_lshlrev_b32 v8, 16, v86
    v_and_b32 v9, 0xffff0000, v86
    v_fmac_f32 v44, v21, v8
    v_fmac_f32 v45, v21, v9
    v_lshlrev_b32 v8, 16, v87
    v_and_b32 v9, 0xffff0000, v87
    v_fmac_f32 v46, v21, v8
    v_fmac_f32 v47, v21, v9
    v_lshlrev_b32 v8, 16, v88
    v_and_b32 v9, 0xffff0000, v88
    v_fmac_f32 v40, v22, v8
    v_fmac_f32 v41, v22, v9
    v_lshlrev_b32 v8, 16, v89
    v_and_b32 v9, 0xffff0000, v89
    v_fmac_f32 v42, v22, v8
    v_fmac_f32 v43, v22, v9
    v_lshlrev_b32 v8, 16, v90
    v_and_b32 v9, 0xffff0000, v90
    v_fmac_f32 v44, v22, v8
    v_fmac_f32 v45, v22, v9
    v_lshlrev_b32 v8, 16, v91
    v_and_b32 v9, 0xffff0000, v91
    v_fmac_f32 v46, v22, v8
    v_fmac_f32 v47, v22, v9
    v_lshlrev_b32 v8, 16, v92
    v_and_b32 v9, 0xffff0000, v92
    v_fmac_f32 v40, v23, v8
    v_fmac_f32 v41, v23, v9
    v_lshlrev_b32 v8, 16, v93
    v_and_b32 v9, 0xffff0000, v93
    v_fmac_f32 v42, v23, v8
    v_fmac_f32 v43, v23, v9
    v_lshlrev_b32 v8, 16, v94
    v_and_b32 v9, 0xffff0000, v94
    v_fmac_f32 v44, v23, v8
    v_fmac_f32 v45, v23, v9
    v_lshlrev_b32 v8, 16, v95
    v_and_b32 v9, 0xffff0000, v95
    v_fmac_f32 v46, v23, v8
    v_fmac_f32 v47, v23, v9
    v_lshlrev_b32 v8, 16, v96
    v_and_b32 v9, 0xffff0000, v96
    v_fmac_f32 v40, v24, v8
    v_fmac_f32 v41, v24, v9
    v_lshlrev_b32 v8, 16, v97
    v_and_b32 v9, 0xffff0000, v97
    v_fmac_f32 v42, v24, v8
    v_fmac_f32 v43, v24, v9
    v_lshlrev_b32 v8, 16, v98
    v_and_b32 v9, 0xffff0000, v98
    v_fmac_f32 v44, v24, v8
    v_fmac_f32 v45, v24, v9
    v_lshlrev_b32 v8, 16, v99
    v_and_b32 v9, 0xffff0000, v99
    v_fmac_f32 v46, v24, v8
    v_fmac_f32 v47, v24, v9
    v_lshlrev_b32 v8, 16, v100
    v_and_b32 v9, 0xffff0000, v100
    v_fmac_f32 v40, v25, v8
    v_fmac_f32 v41, v25, v9
    v_lshlrev_b32 v8, 16, v101
    v_and_b32 v9, 0xffff0000, v101
    v_fmac_f32 v42, v25, v8
    v_fmac_f32 v43, v25, v9
    v_lshlrev_b32 v8, 16, v102
    v_and_b32 v9, 0xffff0000, v102
    v_fmac_f32 v44, v25, v8
    v_fmac_f32 v45, v25, v9
    v_lshlrev_b32 v8, 16, v103
    v_and_b32 v9, 0xffff0000, v103
    v_fmac_f32 v46, v25, v8
    v_fmac_f32 v47, v25, v9
    s_nop 1
    v_permlane32_swap_b32 v40, v44
    v_permlane32_swap_b32 v41, v45
    v_permlane32_swap_b32 v42, v46
    v_permlane32_swap_b32 v43, v47
    v_add_f32 v40, v40, v44
    v_add_f32 v41, v41, v45
    v_add_f32 v42, v42, v46
    v_add_f32 v43, v43, v47
    s_nop 1
    v_permlane16_swap_b32 v40, v42
    v_permlane16_swap_b32 v41, v43
    v_add_f32 v40, v40, v42
    v_add_f32 v41, v41, v43
    s_nop 1
    v_add_f32_dpp v40, v40, v40 row_ror:4 row_mask:0xf bank_mask:0xf
    v_add_f32_dpp v41, v41, v41 row_ror:4 row_mask:0xf bank_mask:0xf
    s_nop 1
    v_add_f32_dpp v40, v40, v40 row_ror:8 row_mask:0xf bank_mask:0xf
    v_add_f32_dpp v41, v41, v41 row_ror:8 row_mask:0xf bank_mask:0xf
    v_lshrrev_b32 v9, 4, v1
    v_and_b32 v8, 1, v9
    v_lshrrev_b32 v9, 1, v9
    v_lshlrev_b32 v8, 3, v8
    v_lshl_add_u32 v8, v9, 4, v8
    v_and_b32 v9, 3, v1
    v_lshl_add_u32 v8, v9, 5, v8
    s_mul_i32 s28, s27, 128
    s_add_u32 s28, s28, 161792
    v_add_u32 v8, s28, v8
    s_mov_b32 exec_lo, 0xf000f
    s_mov_b32 exec_hi, 0xf000f
    ds_write_b64 v8, v[40:41]
    s_mov_b64 exec, -1
    s_waitcnt lgkmcnt(0)
    v_mov_b32 v8, 162824
    v_mov_b32 v9, 1
    s_mov_b64 exec, 1
    ds_add_u32 v8, v9
    s_mov_b64 exec, -1
    s_cmp_lg_u32 s27, 0
    s_cbranch_scc1 .Lp3_done
    v_mov_b32 v8, 162824
.aw_9:
    ds_read_b32 v9, v8
    s_waitcnt lgkmcnt(0)
    v_readfirstlane_b32 s28, v9
    s_nop 0
    s_cmp_lt_u32 s28, 4
    s_cbranch_scc1 .aw_9
    v_add_u32 v8, 161792, v3
    ds_read_b32 v44, v8 offset:0
    ds_read_b32 v45, v8 offset:128
    ds_read_b32 v46, v8 offset:256
    ds_read_b32 v47, v8 offset:384
    s_waitcnt lgkmcnt(0)
    v_add_f32 v44, v44, v45
    v_add_f32 v46, v46, v47
    v_add_f32 v44, v44, v46
    v_cvt_pk_bf16_f32 v8, v44, v44
    v_lshlrev_b32 v44, 16, v8
    v_mov_b32 v8, 0x7fc00000
    v_cmp_eq_u32 vcc, -1, v44
    s_nop 1
    v_cndmask_b32 v44, v44, v8, vcc
    s_lshl_b32 s28, s2, 7
    s_mov_b64 exec, 0xffffffff
    buffer_store_dword v44, v3, s[8:11], s28 offen offset:0 sc0 sc1
    s_mov_b64 exec, -1
.Lp3_done:
    s_setprio 0
    s_cmp_ge_u32 s2, 160
    s_cbranch_scc1 .Lpre_t3
    s_mov_b32 s60, s80
    s_mov_b32 s61, s81
    s_mov_b32 s62, 7864320
    s_mov_b32 s63, 0x00020000
    s_mul_hi_u32 s30, s2, 0x1999999a
    s_mul_i32 s31, s30, 10
    s_sub_u32 s31, s2, s31
    s_mul_i32 s28, s30, 491520
    s_lshl_b32 s31, s31, 7
    s_add_u32 s28, s28, s31
    s_mul_i32 s31, s27, 122880
    s_add_u32 s28, s28, s31
    v_lshrrev_b32 v8, 3, v1
    v_mul_u32_u24 v8, 1280, v8
    v_and_b32 v9, 7, v1
    v_lshl_add_u32 v8, v9, 4, v8
    buffer_load_dwordx4 v[64:67], v8, s[60:63], s28 offen
    s_add_u32 s28, s28, 10240
    buffer_load_dwordx4 v[68:71], v8, s[60:63], s28 offen
    s_add_u32 s28, s28, 10240
    buffer_load_dwordx4 v[72:75], v8, s[60:63], s28 offen
    s_add_u32 s28, s28, 10240
    buffer_load_dwordx4 v[76:79], v8, s[60:63], s28 offen
    s_add_u32 s28, s28, 10240
    buffer_load_dwordx4 v[80:83], v8, s[60:63], s28 offen
    s_add_u32 s28, s28, 10240
    buffer_load_dwordx4 v[84:87], v8, s[60:63], s28 offen
    s_add_u32 s28, s28, 10240
    buffer_load_dwordx4 v[88:91], v8, s[60:63], s28 offen
    s_add_u32 s28, s28, 10240
    buffer_load_dwordx4 v[92:95], v8, s[60:63], s28 offen
    s_add_u32 s28, s28, 10240
    buffer_load_dwordx4 v[96:99], v8, s[60:63], s28 offen
    s_add_u32 s28, s28, 10240
    buffer_load_dwordx4 v[100:103], v8, s[60:63], s28 offen
    s_add_u32 s28, s28, 10240
    buffer_load_dwordx4 v[104:107], v8, s[60:63], s28 offen
    s_add_u32 s28, s28, 10240
    buffer_load_dwordx4 v[108:111], v8, s[60:63], s28 offen
    s_add_u32 s28, s28, 10240
    s_branch .Laux_wait
.Lpre_t3:
    s_cmp_ge_u32 s2, 208
    s_cbranch_scc1 .Lpre_t4
    s_mov_b32 s60, s84
    s_mov_b32 s61, s85
    s_mov_b32 s62, 1966080
    s_mov_b32 s63, 0x00020000
    s_mov_b32 s64, s86
    s_mov_b32 s65, s87
    s_mov_b32 s66, 1966080
    s_mov_b32 s67, 0x00020000
    s_sub_u32 s28, s2, 160
    s_lshl_b32 s28, s28, 6
    v_mul_u32_u24 v8, 3072, v6
    v_lshl_add_u32 v8, v5, 4, v8
    buffer_load_dwordx4 v[64:67], v8, s[60:63], s28 offen
    buffer_load_dwordx4 v[104:107], v8, s[64:67], s28 offen
    s_add_u32 s28, s28, 49152
    buffer_load_dwordx4 v[68:71], v8, s[60:63], s28 offen
    buffer_load_dwordx4 v[108:111], v8, s[64:67], s28 offen
    s_add_u32 s28, s28, 49152
    buffer_load_dwordx4 v[72:75], v8, s[60:63], s28 offen
    buffer_load_dwordx4 v[112:115], v8, s[64:67], s28 offen
    s_add_u32 s28, s28, 49152
    buffer_load_dwordx4 v[76:79], v8, s[60:63], s28 offen
    buffer_load_dwordx4 v[116:119], v8, s[64:67], s28 offen
    s_add_u32 s28, s28, 49152
    buffer_load_dwordx4 v[80:83], v8, s[60:63], s28 offen
    buffer_load_dwordx4 v[120:123], v8, s[64:67], s28 offen
    s_add_u32 s28, s28, 49152
    buffer_load_dwordx4 v[84:87], v8, s[60:63], s28 offen
    buffer_load_dwordx4 v[124:127], v8, s[64:67], s28 offen
    s_add_u32 s28, s28, 49152
    buffer_load_dwordx4 v[88:91], v8, s[60:63], s28 offen
    buffer_load_dwordx4 v[128:131], v8, s[64:67], s28 offen
    s_add_u32 s28, s28, 49152
    buffer_load_dwordx4 v[92:95], v8, s[60:63], s28 offen
    buffer_load_dwordx4 v[132:135], v8, s[64:67], s28 offen
    s_add_u32 s28, s28, 49152
    buffer_load_dwordx4 v[96:99], v8, s[60:63], s28 offen
    buffer_load_dwordx4 v[136:139], v8, s[64:67], s28 offen
    s_add_u32 s28, s28, 49152
    buffer_load_dwordx4 v[100:103], v8, s[60:63], s28 offen
    buffer_load_dwordx4 v[140:143], v8, s[64:67], s28 offen
    s_add_u32 s28, s28, 49152
    s_mov_b32 s39, 0
.pc_10:
    buffer_load_dword v53, v52, s[12:15], 0 offen offset:128 sc1
    s_waitcnt vmcnt(0)
    v_readfirstlane_b32 s38, v53
    s_nop 0
    s_cmp_ge_u32 s38, 256
    s_cbranch_scc1 .pcd_11
    s_add_u32 s39, s39, 1
    s_cmp_gt_u32 s39, 400000
    s_cbranch_scc1 .pcd_11
    s_sleep 1
    s_branch .pc_10
.pcd_11:
    s_mov_b32 s39, 0
.poll_12:
    s_mov_b32 s29, 7680
    buffer_load_dword v144, v14, s[8:11], s29 offen offset:0 sc1
    buffer_load_dword v145, v14, s[8:11], s29 offen offset:64 sc1
    buffer_load_dword v146, v14, s[8:11], s29 offen offset:128 sc1
    buffer_load_dword v147, v14, s[8:11], s29 offen offset:192 sc1
    buffer_load_dword v148, v14, s[8:11], s29 offen offset:256 sc1
    buffer_load_dword v149, v14, s[8:11], s29 offen offset:320 sc1
    buffer_load_dword v150, v14, s[8:11], s29 offen offset:384 sc1
    buffer_load_dword v151, v14, s[8:11], s29 offen offset:448 sc1
    buffer_load_dword v152, v14, s[8:11], s29 offen offset:512 sc1
    buffer_load_dword v153, v14, s[8:11], s29 offen offset:576 sc1
    s_mov_b32 s29, 10240
    buffer_load_dword v154, v14, s[8:11], s29 offen offset:0 sc1
    buffer_load_dword v155, v14, s[8:11], s29 offen offset:64 sc1
    buffer_load_dword v156, v14, s[8:11], s29 offen offset:128 sc1
    buffer_load_dword v157, v14, s[8:11], s29 offen offset:192 sc1
    buffer_load_dword v158, v14, s[8:11], s29 offen offset:256 sc1
    buffer_load_dword v159, v14, s[8:11], s29 offen offset:320 sc1
    buffer_load_dword v160, v14, s[8:11], s29 offen offset:384 sc1
    buffer_load_dword v161, v14, s[8:11], s29 offen offset:448 sc1
    buffer_load_dword v162, v14, s[8:11], s29 offen offset:512 sc1
    buffer_load_dword v163, v14, s[8:11], s29 offen offset:576 sc1
    s_waitcnt vmcnt(0)
    v_mov_b32 v53, v144
    v_max3_u32 v53, v53, v145, v146
    v_max3_u32 v53, v53, v147, v148
    v_max3_u32 v53, v53, v149, v150
    v_max3_u32 v53, v53, v151, v152
    v_max3_u32 v53, v53, v153, v154
    v_max3_u32 v53, v53, v155, v156
    v_max3_u32 v53, v53, v157, v158
    v_max3_u32 v53, v53, v159, v160
    v_max3_u32 v53, v53, v161, v162
    v_max_u32 v53, v53, v163
    v_cmp_eq_u32 vcc, -1, v53
    s_cbranch_vccz .polld_13
    s_add_u32 s39, s39, 1
    s_cmp_gt_u32 s39, 400000
    s_cbranch_scc1 .polld_13
    s_sleep 1
    s_branch .poll_12
.polld_13:
    v_add_f32 v154, 1.0, v154
    v_cvt_pk_bf16_f32 v10, v154, v154
    v_lshlrev_b32 v154, 16, v10
    v_add_f32 v155, 1.0, v155
    v_cvt_pk_bf16_f32 v10, v155, v155
    v_lshlrev_b32 v155, 16, v10
    v_add_f32 v156, 1.0, v156
    v_cvt_pk_bf16_f32 v10, v156, v156
    v_lshlrev_b32 v156, 16, v10
    v_add_f32 v157, 1.0, v157
    v_cvt_pk_bf16_f32 v10, v157, v157
    v_lshlrev_b32 v157, 16, v10
    v_add_f32 v158, 1.0, v158
    v_cvt_pk_bf16_f32 v10, v158, v158
    v_lshlrev_b32 v158, 16, v10
    v_add_f32 v159, 1.0, v159
    v_cvt_pk_bf16_f32 v10, v159, v159
    v_lshlrev_b32 v159, 16, v10
    v_add_f32 v160, 1.0, v160
    v_cvt_pk_bf16_f32 v10, v160, v160
    v_lshlrev_b32 v160, 16, v10
    v_add_f32 v161, 1.0, v161
    v_cvt_pk_bf16_f32 v10, v161, v161
    v_lshlrev_b32 v161, 16, v10
    v_add_f32 v162, 1.0, v162
    v_cvt_pk_bf16_f32 v10, v162, v162
    v_lshlrev_b32 v162, 16, v10
    v_add_f32 v163, 1.0, v163
    v_cvt_pk_bf16_f32 v10, v163, v163
    v_lshlrev_b32 v163, 16, v10
    s_branch .Laux_wait
.Lpre_t4:
    s_cmp_ge_u32 s2, 248
    s_cbranch_scc1 .Laux_wait
    s_mov_b32 s60, s88
    s_mov_b32 s61, s89
    s_mov_b32 s62, 1966080
    s_mov_b32 s63, 0x00020000
    s_sub_u32 s28, s2, 208
    s_lshl_b32 s28, s28, 5
    s_mul_i32 s31, s27, 491520
    s_add_u32 s28, s28, s31
    v_lshrrev_b32 v8, 1, v1
    v_mul_u32_u24 v8, 1280, v8
    v_and_b32 v9, 1, v1
    v_lshl_add_u32 v8, v9, 4, v8
    buffer_load_dwordx4 v[64:67], v8, s[60:63], s28 offen
    s_add_u32 s28, s28, 40960
    buffer_load_dwordx4 v[68:71], v8, s[60:63], s28 offen
    s_add_u32 s28, s28, 40960
    buffer_load_dwordx4 v[72:75], v8, s[60:63], s28 offen
    s_add_u32 s28, s28, 40960
    buffer_load_dwordx4 v[76:79], v8, s[60:63], s28 offen
    s_add_u32 s28, s28, 40960
    buffer_load_dwordx4 v[80:83], v8, s[60:63], s28 offen
    s_add_u32 s28, s28, 40960
    buffer_load_dwordx4 v[84:87], v8, s[60:63], s28 offen
    s_add_u32 s28, s28, 40960
    buffer_load_dwordx4 v[88:91], v8, s[60:63], s28 offen
    s_add_u32 s28, s28, 40960
    buffer_load_dwordx4 v[92:95], v8, s[60:63], s28 offen
    s_add_u32 s28, s28, 40960
    buffer_load_dwordx4 v[96:99], v8, s[60:63], s28 offen
    s_add_u32 s28, s28, 40960
    buffer_load_dwordx4 v[100:103], v8, s[60:63], s28 offen
    s_add_u32 s28, s28, 40960
    buffer_load_dwordx4 v[104:107], v8, s[60:63], s28 offen
    s_add_u32 s28, s28, 40960
    buffer_load_dwordx4 v[108:111], v8, s[60:63], s28 offen
    s_add_u32 s28, s28, 40960
.Laux_wait:
    s_mov_b32 s39, 0
.pc_14:
    buffer_load_dword v53, v52, s[12:15], 0 offen offset:128 sc1
    s_waitcnt vmcnt(0)
    v_readfirstlane_b32 s38, v53
    s_nop 0
    s_cmp_ge_u32 s38, 256
    s_cbranch_scc1 .pcd_15
    s_add_u32 s39, s39, 1
    s_cmp_gt_u32 s39, 400000
    s_cbranch_scc1 .pcd_15
    s_sleep 1
    s_branch .pc_14
.pcd_15:
    s_waitcnt vmcnt(0) lgkmcnt(0)
    s_branch .Ltail
.Lstream:
    s_barrier
    s_mov_b32 s4, s74
    s_mov_b32 s5, s75
    s_mov_b32 s6, 402653184
    s_mov_b32 s7, 0x00020000
    s_lshl_b32 s27, s26, 2
    s_add_u32 s27, s27, s20
    s_mul_i32 s24, s25, 25165824
    s_mul_i32 s23, s20, 36864
    s_mov_b32 s22, 0
    s_mov_b32 s21, 0
    s_mov_b32 s67, 0
    s_mov_b32 s68, 0
    s_mul_i32 s32, s20, 1792
    s_add_u32 s32, s32, 147456
    s_and_b32 s54, s25, 3
    s_lshl_b32 s54, s54, 6
    s_lshr_b32 s55, s25, 2
    s_lshl_b32 s55, s55, 2
    s_add_u32 s54, s54, s55
    s_add_u32 s54, s54, 16
    s_mov_b32 s44, 0
    s_mov_b32 s45, 0
    s_mov_b32 s46, -2
    s_mov_b32 s49, 0x7fffffff
    s_mov_b32 s47, 0
    s_mov_b32 s48, 0
    v_mov_b32 v52, 0
    v_mov_b32 v63, 0
    v_add_u32 v2, 0, v1
    v_mul_u32_u24 v2, 2731, v2
    v_lshrrev_b32 v2, 16, v2
    v_and_b32 v2, 6, v2
    v_lshlrev_b32 v2, 4, v2
    v_lshlrev_b32 v5, 4, v1
    v_xor_b32 v2, v2, v5
    v_add_u32 v3, 64, v1
    v_mul_u32_u24 v3, 2731, v3
    v_lshrrev_b32 v3, 16, v3
    v_and_b32 v3, 6, v3
    v_lshlrev_b32 v3, 4, v3
    v_lshlrev_b32 v5, 4, v1
    v_xor_b32 v3, v3, v5
    v_add_u32 v4, 128, v1
    v_mul_u32_u24 v4, 2731, v4
    v_lshrrev_b32 v4, 16, v4
    v_and_b32 v4, 6, v4
    v_lshlrev_b32 v4, 4, v4
    v_lshlrev_b32 v5, 4, v1
    v_xor_b32 v4, v4, v5
    s_cmp_ge_u32 s2, 40
    s_cbranch_scc1 .Lnogate
    v_mov_b32 v53, 162828
    s_mov_b32 s31, 4
.Lgate:
    ds_read_b32 v54, v53
    s_waitcnt lgkmcnt(0)
    v_readfirstlane_b32 s28, v54
    s_nop 0
    s_cmp_ge_u32 s28, s31
    s_cbranch_scc1 .Lnogate
    s_sleep 1
    s_branch .Lgate
.Lnogate:
.Lg_top1:
    s_cmp_ge_u32 s44, 2
    s_cbranch_scc1 .Lg_v1
    s_cmp_lt_u32 s45, 7
    s_cbranch_scc1 .Lg_static1
    s_cmp_lg_u32 s49, 0x7fffffff
    s_cbranch_scc1 .Lg_bk1
    v_mov_b32 v62, 162844
.Lg_bs1:
    ds_read_b32 v59, v62
    s_waitcnt lgkmcnt(0)
    v_readfirstlane_b32 s49, v59
    s_nop 0
    s_cmp_eq_u32 s49, 0x7fffffff
    s_cbranch_scc0 .Lg_bk1
    s_sleep 1
    s_branch .Lg_bs1
.Lg_bk1:
    s_cmp_eq_u32 s44, 0
    s_cselect_b32 s28, 2, 2
    s_mul_i32 s28, s28, s49
    s_add_u32 s28, s28, 4
    s_and_b32 s29, s2, 1
    s_cmp_eq_u32 s29, 0
    s_cselect_b32 s29, 0, s28
    s_cselect_b32 s30, s28, 8
    s_sub_u32 s28, s45, 7
    s_lshl_b32 s28, s28, 2
    s_add_u32 s28, s28, s20
    s_add_u32 s28, s28, s29
    s_cmp_ge_u32 s28, s30
    s_cbranch_scc1 .Lg_next1
    s_add_u32 s45, s45, 1
    s_lshr_b32 s29, s26, 1
    s_lshl_b32 s29, s29, 3
    s_add_u32 s28, s28, s29
    s_add_u32 s28, s28, 448
    s_branch .Lg_rec1
.Lg_next1:
    s_add_u32 s44, s44, 1
    s_mov_b32 s45, 0
    s_branch .Lg_top1
.Lg_static1:
    s_mul_i32 s28, s27, 7
    s_add_u32 s28, s28, s45
    s_add_u32 s45, s45, 1
.Lg_rec1:
    s_cmp_eq_u32 s44, 0
    s_cselect_b32 s29, s47, s48
    s_lshl_b32 s30, s44, 4
    s_add_u32 s30, s30, s29
    s_add_u32 s29, s29, 1
    s_cmp_eq_u32 s44, 0
    s_cselect_b32 s47, s29, s47
    s_cselect_b32 s48, s48, s29
    s_mov_b32 m0, s30
    s_nop 0
    v_writelane_b32 v63, s28, m0
    s_branch .Lg_emit1
.Lg_v1:
    s_cmp_ge_u32 s44, 4
    s_cbranch_scc1 .Lg_end1
    s_cmp_eq_u32 s44, 2
    s_cselect_b32 s29, s47, s48
    s_cmp_lt_u32 s45, s29
    s_cbranch_scc1 .Lg_rep1
    s_add_u32 s44, s44, 1
    s_mov_b32 s45, 0
    s_branch .Lg_v1
.Lg_rep1:
    s_sub_u32 s30, s44, 2
    s_lshl_b32 s30, s30, 4
    s_add_u32 s30, s30, s45
    s_add_u32 s45, s45, 1
    s_nop 1
    v_readlane_b32 s28, v63, s30
.Lg_emit1:
    s_lshl_b32 s29, s44, 9
    s_or_b32 s60, s29, s28
    s_and_b32 s29, s44, 1
    s_mul_i32 s29, s29, 12582912
    s_mul_i32 s28, s28, 24576
    s_add_u32 s28, s28, s29
    s_add_u32 s63, s28, s24
    s_branch .Lg_out1
.Lg_end1:
    s_mov_b32 s60, -1
    s_mov_b32 s63, 0x80000000
.Lg_out1:
.Lg_top2:
    s_cmp_ge_u32 s44, 2
    s_cbranch_scc1 .Lg_v2
    s_cmp_lt_u32 s45, 7
    s_cbranch_scc1 .Lg_static2
    s_cmp_lg_u32 s49, 0x7fffffff
    s_cbranch_scc1 .Lg_bk2
    v_mov_b32 v62, 162844
.Lg_bs2:
    ds_read_b32 v59, v62
    s_waitcnt lgkmcnt(0)
    v_readfirstlane_b32 s49, v59
    s_nop 0
    s_cmp_eq_u32 s49, 0x7fffffff
    s_cbranch_scc0 .Lg_bk2
    s_sleep 1
    s_branch .Lg_bs2
.Lg_bk2:
    s_cmp_eq_u32 s44, 0
    s_cselect_b32 s28, 2, 2
    s_mul_i32 s28, s28, s49
    s_add_u32 s28, s28, 4
    s_and_b32 s29, s2, 1
    s_cmp_eq_u32 s29, 0
    s_cselect_b32 s29, 0, s28
    s_cselect_b32 s30, s28, 8
    s_sub_u32 s28, s45, 7
    s_lshl_b32 s28, s28, 2
    s_add_u32 s28, s28, s20
    s_add_u32 s28, s28, s29
    s_cmp_ge_u32 s28, s30
    s_cbranch_scc1 .Lg_next2
    s_add_u32 s45, s45, 1
    s_lshr_b32 s29, s26, 1
    s_lshl_b32 s29, s29, 3
    s_add_u32 s28, s28, s29
    s_add_u32 s28, s28, 448
    s_branch .Lg_rec2
.Lg_next2:
    s_add_u32 s44, s44, 1
    s_mov_b32 s45, 0
    s_branch .Lg_top2
.Lg_static2:
    s_mul_i32 s28, s27, 7
    s_add_u32 s28, s28, s45
    s_add_u32 s45, s45, 1
.Lg_rec2:
    s_cmp_eq_u32 s44, 0
    s_cselect_b32 s29, s47, s48
    s_lshl_b32 s30, s44, 4
    s_add_u32 s30, s30, s29
    s_add_u32 s29, s29, 1
    s_cmp_eq_u32 s44, 0
    s_cselect_b32 s47, s29, s47
    s_cselect_b32 s48, s48, s29
    s_mov_b32 m0, s30
    s_nop 0
    v_writelane_b32 v63, s28, m0
    s_branch .Lg_emit2
.Lg_v2:
    s_cmp_ge_u32 s44, 4
    s_cbranch_scc1 .Lg_end2
    s_cmp_eq_u32 s44, 2
    s_cselect_b32 s29, s47, s48
    s_cmp_lt_u32 s45, s29
    s_cbranch_scc1 .Lg_rep2
    s_add_u32 s44, s44, 1
    s_mov_b32 s45, 0
    s_branch .Lg_v2
.Lg_rep2:
    s_sub_u32 s30, s44, 2
    s_lshl_b32 s30, s30, 4
    s_add_u32 s30, s30, s45
    s_add_u32 s45, s45, 1
    s_nop 1
    v_readlane_b32 s28, v63, s30
.Lg_emit2:
    s_lshl_b32 s29, s44, 9
    s_or_b32 s61, s29, s28
    s_and_b32 s29, s44, 1
    s_mul_i32 s29, s29, 12582912
    s_mul_i32 s28, s28, 24576
    s_add_u32 s28, s28, s29
    s_add_u32 s64, s28, s24
    s_branch .Lg_out2
.Lg_end2:
    s_mov_b32 s61, -1
    s_mov_b32 s64, 0x80000000
.Lg_out2:
    s_cmp_lt_u32 s60, 1024
    s_cselect_b32 s4, s16, s18
    s_cselect_b32 s5, s17, s19
    s_add_u32 s29, s63, 0
    s_add_u32 m0, s23, s22
    s_add_u32 s30, s29, 3072
    buffer_load_dwordx4 v2, s[4:7], s29 offen offset:0 nt lds
    buffer_load_dwordx4 v3, s[4:7], s29 offen offset:1024 nt lds
    buffer_load_dwordx4 v4, s[4:7], s29 offen offset:2048 nt lds
    s_add_u32 m0, m0, 3072
    s_nop 0
    buffer_load_dwordx4 v2, s[4:7], s30 offen offset:0 nt lds
    buffer_load_dwordx4 v3, s[4:7], s30 offen offset:1024 nt lds
    buffer_load_dwordx4 v4, s[4:7], s30 offen offset:2048 nt lds
    s_add_u32 s22, s22, 6144
    s_cmp_eq_u32 s22, 36864
    s_cselect_b32 s22, 0, s22
    s_cmp_lt_u32 s60, 1024
    s_cselect_b32 s4, s16, s18
    s_cselect_b32 s5, s17, s19
    s_add_u32 s29, s63, 6144
    s_add_u32 m0, s23, s22
    s_add_u32 s30, s29, 3072
    buffer_load_dwordx4 v2, s[4:7], s29 offen offset:0 nt lds
    buffer_load_dwordx4 v3, s[4:7], s29 offen offset:1024 nt lds
    buffer_load_dwordx4 v4, s[4:7], s29 offen offset:2048 nt lds
    s_add_u32 m0, m0, 3072
    s_nop 0
    buffer_load_dwordx4 v2, s[4:7], s30 offen offset:0 nt lds
    buffer_load_dwordx4 v3, s[4:7], s30 offen offset:1024 nt lds
    buffer_load_dwordx4 v4, s[4:7], s30 offen offset:2048 nt lds
    s_add_u32 s22, s22, 6144
    s_cmp_eq_u32 s22, 36864
    s_cselect_b32 s22, 0, s22
    s_cmp_lt_u32 s60, 1024
    s_cselect_b32 s4, s16, s18
    s_cselect_b32 s5, s17, s19
    s_add_u32 s29, s63, 12288
    s_add_u32 m0, s23, s22
    s_add_u32 s30, s29, 3072
    buffer_load_dwordx4 v2, s[4:7], s29 offen offset:0 nt lds
    buffer_load_dwordx4 v3, s[4:7], s29 offen offset:1024 nt lds
    buffer_load_dwordx4 v4, s[4:7], s29 offen offset:2048 nt lds
    s_add_u32 m0, m0, 3072
    s_nop 0
    buffer_load_dwordx4 v2, s[4:7], s30 offen offset:0 nt lds
    buffer_load_dwordx4 v3, s[4:7], s30 offen offset:1024 nt lds
    buffer_load_dwordx4 v4, s[4:7], s30 offen offset:2048 nt lds
    s_add_u32 s22, s22, 6144
    s_cmp_eq_u32 s22, 36864
    s_cselect_b32 s22, 0, s22
    s_waitcnt vmcnt(12)
    s_cmp_lt_u32 s60, 1024
    s_cselect_b32 s4, s16, s18
    s_cselect_b32 s5, s17, s19
    s_add_u32 s29, s63, 18432
    s_add_u32 m0, s23, s22
    s_add_u32 s30, s29, 3072
    buffer_load_dwordx4 v2, s[4:7], s29 offen offset:0 nt lds
    buffer_load_dwordx4 v3, s[4:7], s29 offen offset:1024 nt lds
    buffer_load_dwordx4 v4, s[4:7], s29 offen offset:2048 nt lds
    s_add_u32 m0, m0, 3072
    s_nop 0
    buffer_load_dwordx4 v2, s[4:7], s30 offen offset:0 nt lds
    buffer_load_dwordx4 v3, s[4:7], s30 offen offset:1024 nt lds
    buffer_load_dwordx4 v4, s[4:7], s30 offen offset:2048 nt lds
    s_add_u32 s22, s22, 6144
    s_cmp_eq_u32 s22, 36864
    s_cselect_b32 s22, 0, s22
    s_waitcnt vmcnt(12)
    s_cmp_lt_u32 s61, 1024
    s_cselect_b32 s4, s16, s18
    s_cselect_b32 s5, s17, s19
    s_add_u32 s29, s64, 0
    s_add_u32 m0, s23, s22
    s_add_u32 s30, s29, 3072
    buffer_load_dwordx4 v2, s[4:7], s29 offen offset:0 nt lds
    buffer_load_dwordx4 v3, s[4:7], s29 offen offset:1024 nt lds
    buffer_load_dwordx4 v4, s[4:7], s29 offen offset:2048 nt lds
    s_add_u32 m0, m0, 3072
    s_nop 0
    buffer_load_dwordx4 v2, s[4:7], s30 offen offset:0 nt lds
    buffer_load_dwordx4 v3, s[4:7], s30 offen offset:1024 nt lds
    buffer_load_dwordx4 v4, s[4:7], s30 offen offset:2048 nt lds
    s_add_u32 s22, s22, 6144
    s_cmp_eq_u32 s22, 36864
    s_cselect_b32 s22, 0, s22
    s_waitcnt vmcnt(12)
    s_cmp_lt_u32 s61, 1024
    s_cselect_b32 s4, s16, s18
    s_cselect_b32 s5, s17, s19
    s_add_u32 s29, s64, 6144
    s_add_u32 m0, s23, s22
    s_add_u32 s30, s29, 3072
    buffer_load_dwordx4 v2, s[4:7], s29 offen offset:0 nt lds
    buffer_load_dwordx4 v3, s[4:7], s29 offen offset:1024 nt lds
    buffer_load_dwordx4 v4, s[4:7], s29 offen offset:2048 nt lds
    s_add_u32 m0, m0, 3072
    s_nop 0
    buffer_load_dwordx4 v2, s[4:7], s30 offen offset:0 nt lds
    buffer_load_dwordx4 v3, s[4:7], s30 offen offset:1024 nt lds
    buffer_load_dwordx4 v4, s[4:7], s30 offen offset:2048 nt lds
    s_add_u32 s22, s22, 6144
    s_cmp_eq_u32 s22, 36864
    s_cselect_b32 s22, 0, s22
    s_waitcnt vmcnt(12)
    s_add_u32 s29, s64, 12288
    s_add_u32 s30, s29, 3072
    buffer_load_dwordx4 v[200:203], v2, s[4:7], s29 offen offset:0 nt
    buffer_load_dwordx4 v[204:207], v3, s[4:7], s29 offen offset:1024 nt
    buffer_load_dwordx4 v[208:211], v4, s[4:7], s29 offen offset:2048 nt
    buffer_load_dwordx4 v[212:215], v2, s[4:7], s30 offen offset:0 nt
    buffer_load_dwordx4 v[216:219], v3, s[4:7], s30 offen offset:1024 nt
    buffer_load_dwordx4 v[220:223], v4, s[4:7], s30 offen offset:2048 nt
    s_add_u32 s29, s64, 18432
    s_add_u32 s30, s29, 3072
    buffer_load_dwordx4 v[224:227], v2, s[4:7], s29 offen offset:0 nt
    buffer_load_dwordx4 v[228:231], v3, s[4:7], s29 offen offset:1024 nt
    buffer_load_dwordx4 v[232:235], v4, s[4:7], s29 offen offset:2048 nt
    buffer_load_dwordx4 v[236:239], v2, s[4:7], s30 offen offset:0 nt
    buffer_load_dwordx4 v[240:243], v3, s[4:7], s30 offen offset:1024 nt
    buffer_load_dwordx4 v[244:247], v4, s[4:7], s30 offen offset:2048 nt
    s_mov_b32 s68, 2
    v_lshrrev_b32 v6, 4, v1
    v_and_b32 v7, 15, v1
    v_lshlrev_b32 v8, 4, v6
    v_and_b32 v9, 6, v7
    v_xor_b32 v10, v6, v9
    v_xor_b32 v11, 4, v10
    v_mul_u32_u24 v12, 384, v7
    v_add_u32 v12, s23, v12
    v_lshl_add_u32 v10, v10, 4, v12
    v_lshl_add_u32 v11, v11, 4, v12
    v_bfe_u32 v40, v1, 2, 2
    v_and_b32 v41, 3, v1
    v_and_b32 v42, 1, v6
    v_lshlrev_b32 v42, 1, v42
    v_lshrrev_b32 v43, 1, v40
    v_or_b32 v42, v42, v43
    v_lshl_add_u32 v43, v6, 2, v40
    v_mul_u32_u24 v43, 384, v43
    v_lshl_add_u32 v43, v41, 3, v43
    v_add_u32 v43, s23, v43
    v_xor_b32 v44, 0, v42
    v_lshl_add_u32 v12, v44, 5, v43
    v_xor_b32 v44, 1, v42
    v_lshl_add_u32 v13, v44, 5, v43
    v_xor_b32 v44, 2, v42
    v_lshl_add_u32 v14, v44, 5, v43
    v_xor_b32 v44, 3, v42
    v_lshl_add_u32 v15, v44, 5, v43
    v_mov_b32 v53, 160512
    s_cmp_lg_u32 s20, 0
    s_cbranch_scc1 .Lq_wait
    s_mov_b32 s39, 0
.gn_16:
    buffer_load_dword v54, v52, s[12:15], 0 offen sc1
    s_waitcnt vmcnt(0)
    v_readfirstlane_b32 s70, v54
    s_nop 0
    s_cmp_lg_u32 s70, 0
    s_cbranch_scc1 .gnd_17
    s_add_u32 s39, s39, 1
    s_cmp_gt_u32 s39, 400000
    s_cbranch_scc1 .gnd_17
    s_sleep 2
    s_branch .gn_16
.gnd_17:
    s_mul_i32 s31, s25, 1536
    s_add_u32 s31, s31, 524288
    v_lshlrev_b32 v55, 4, v1
    v_min_u32 v56, 496, v55
    s_mov_b32 s39, 0
.pt_18:
    buffer_load_dwordx4 v[16:19], v55, s[8:11], s31 offen sc1
    buffer_load_dwordx4 v[20:23], v56, s[8:11], s31 offen offset:1024 sc1
    s_waitcnt vmcnt(0)
    v_xor_b32 v44, s70, v17
    v_xor_b32 v45, s70, v19
    v_or_b32 v44, v44, v45
    v_xor_b32 v45, s70, v21
    v_or_b32 v44, v44, v45
    v_xor_b32 v45, s70, v23
    v_or_b32 v44, v44, v45
    v_cmp_ne_u32 vcc, 0, v44
    s_cbranch_vccz .ptd_19
    s_add_u32 s39, s39, 1
    s_cmp_gt_u32 s39, 400000
    s_cbranch_scc1 .ptd_19
    s_sleep 2
    s_branch .pt_18
.ptd_19:
    v_mov_b32 v17, v18
    v_mov_b32 v21, v22
    v_lshrrev_b32 v55, 1, v55
    v_lshrrev_b32 v56, 1, v56
    v_add_u32 v55, 159744, v55
    v_add_u32 v56, 160256, v56
    ds_write_b64 v55, v[16:17]
    ds_write_b64 v56, v[20:21]
    s_waitcnt lgkmcnt(0)
    v_mov_b32 v54, 1
    ds_write_b32 v53, v54
.Lq_wait:
    ds_read_b32 v54, v53
    s_waitcnt lgkmcnt(0)
    v_readfirstlane_b32 s28, v54
    s_nop 0
    s_cmp_eq_u32 s28, 1
    s_cbranch_scc1 .Lq_ok
    s_sleep 1
    s_branch .Lq_wait
.Lq_ok:
    v_add_u32 v55, 159744, v8
    ds_read_b128 v[16:19], v55 offset:0
    ds_read_b128 v[20:23], v55 offset:64
    ds_read_b128 v[24:27], v55 offset:128
    ds_read_b128 v[28:31], v55 offset:192
    ds_read_b128 v[32:35], v55 offset:256
    ds_read_b128 v[36:39], v55 offset:320
    ds_read_b128 v[176:179], v55 offset:384
    ds_read_b128 v[180:183], v55 offset:448
    ds_read_b128 v[184:187], v55 offset:512
    ds_read_b128 v[188:191], v55 offset:576
    ds_read_b128 v[192:195], v55 offset:640
    ds_read_b128 v[196:199], v55 offset:704
    s_waitcnt lgkmcnt(0)
    s_waitcnt vmcnt(0)
    v_cmp_eq_u32 vcc, 0, v7
    s_nop 1
    v_cndmask_b32 v64, 0, v16, vcc
    v_cndmask_b32 v65, 0, v17, vcc
    v_cndmask_b32 v66, 0, v18, vcc
    v_cndmask_b32 v67, 0, v19, vcc
    v_cndmask_b32 v68, 0, v20, vcc
    v_cndmask_b32 v69, 0, v21, vcc
    v_cndmask_b32 v70, 0, v22, vcc
    v_cndmask_b32 v71, 0, v23, vcc
    v_cndmask_b32 v72, 0, v24, vcc
    v_cndmask_b32 v73, 0, v25, vcc
    v_cndmask_b32 v74, 0, v26, vcc
    v_cndmask_b32 v75, 0, v27, vcc
    v_cndmask_b32 v76, 0, v28, vcc
    v_cndmask_b32 v77, 0, v29, vcc
    v_cndmask_b32 v78, 0, v30, vcc
    v_cndmask_b32 v79, 0, v31, vcc
    v_cndmask_b32 v80, 0, v32, vcc
    v_cndmask_b32 v81, 0, v33, vcc
    v_cndmask_b32 v82, 0, v34, vcc
    v_cndmask_b32 v83, 0, v35, vcc
    v_cndmask_b32 v84, 0, v36, vcc
    v_cndmask_b32 v85, 0, v37, vcc
    v_cndmask_b32 v86, 0, v38, vcc
    v_cndmask_b32 v87, 0, v39, vcc
    v_cmp_eq_u32 vcc, 4, v7
    s_nop 1
    v_cndmask_b32 v88, 0, v16, vcc
    v_cndmask_b32 v89, 0, v17, vcc
    v_cndmask_b32 v90, 0, v18, vcc
    v_cndmask_b32 v91, 0, v19, vcc
    v_cndmask_b32 v92, 0, v20, vcc
    v_cndmask_b32 v93, 0, v21, vcc
    v_cndmask_b32 v94, 0, v22, vcc
    v_cndmask_b32 v95, 0, v23, vcc
    v_cndmask_b32 v96, 0, v24, vcc
    v_cndmask_b32 v97, 0, v25, vcc
    v_cndmask_b32 v98, 0, v26, vcc
    v_cndmask_b32 v99, 0, v27, vcc
    v_cndmask_b32 v100, 0, v28, vcc
    v_cndmask_b32 v101, 0, v29, vcc
    v_cndmask_b32 v102, 0, v30, vcc
    v_cndmask_b32 v103, 0, v31, vcc
    v_cndmask_b32 v104, 0, v32, vcc
    v_cndmask_b32 v105, 0, v33, vcc
    v_cndmask_b32 v106, 0, v34, vcc
    v_cndmask_b32 v107, 0, v35, vcc
    v_cndmask_b32 v108, 0, v36, vcc
    v_cndmask_b32 v109, 0, v37, vcc
    v_cndmask_b32 v110, 0, v38, vcc
    v_cndmask_b32 v111, 0, v39, vcc
    v_cmp_eq_u32 vcc, 8, v7
    s_nop 1
    v_cndmask_b32 v112, 0, v16, vcc
    v_cndmask_b32 v113, 0, v17, vcc
    v_cndmask_b32 v114, 0, v18, vcc
    v_cndmask_b32 v115, 0, v19, vcc
    v_cndmask_b32 v116, 0, v20, vcc
    v_cndmask_b32 v117, 0, v21, vcc
    v_cndmask_b32 v118, 0, v22, vcc
    v_cndmask_b32 v119, 0, v23, vcc
    v_cndmask_b32 v120, 0, v24, vcc
    v_cndmask_b32 v121, 0, v25, vcc
    v_cndmask_b32 v122, 0, v26, vcc
    v_cndmask_b32 v123, 0, v27, vcc
    v_cndmask_b32 v124, 0, v28, vcc
    v_cndmask_b32 v125, 0, v29, vcc
    v_cndmask_b32 v126, 0, v30, vcc
    v_cndmask_b32 v127, 0, v31, vcc
    v_cndmask_b32 v128, 0, v32, vcc
    v_cndmask_b32 v129, 0, v33, vcc
    v_cndmask_b32 v130, 0, v34, vcc
    v_cndmask_b32 v131, 0, v35, vcc
    v_cndmask_b32 v132, 0, v36, vcc
    v_cndmask_b32 v133, 0, v37, vcc
    v_cndmask_b32 v134, 0, v38, vcc
    v_cndmask_b32 v135, 0, v39, vcc
    v_cmp_eq_u32 vcc, 12, v7
    s_nop 1
    v_cndmask_b32 v136, 0, v16, vcc
    v_cndmask_b32 v137, 0, v17, vcc
    v_cndmask_b32 v138, 0, v18, vcc
    v_cndmask_b32 v139, 0, v19, vcc
    v_cndmask_b32 v140, 0, v20, vcc
    v_cndmask_b32 v141, 0, v21, vcc
    v_cndmask_b32 v142, 0, v22, vcc
    v_cndmask_b32 v143, 0, v23, vcc
    v_cndmask_b32 v144, 0, v24, vcc
    v_cndmask_b32 v145, 0, v25, vcc
    v_cndmask_b32 v146, 0, v26, vcc
    v_cndmask_b32 v147, 0, v27, vcc
    v_cndmask_b32 v148, 0, v28, vcc
    v_cndmask_b32 v149, 0, v29, vcc
    v_cndmask_b32 v150, 0, v30, vcc
    v_cndmask_b32 v151, 0, v31, vcc
    v_cndmask_b32 v152, 0, v32, vcc
    v_cndmask_b32 v153, 0, v33, vcc
    v_cndmask_b32 v154, 0, v34, vcc
    v_cndmask_b32 v155, 0, v35, vcc
    v_cndmask_b32 v156, 0, v36, vcc
    v_cndmask_b32 v157, 0, v37, vcc
    v_cndmask_b32 v158, 0, v38, vcc
    v_cndmask_b32 v159, 0, v39, vcc
    v_mov_b32 v54, 0xff800000
    v_mov_b32 v45, 0
    v_lshlrev_b32 v55, 1, v1
    s_add_u32 s34, s32, 0
    v_add_u32 v55, s34, v55
    s_mov_b32 s66, 0
.kloop_20:
    s_waitcnt vmcnt(30)
    v_add_u32 v160, s21, v10
    v_add_u32 v161, s21, v11
    ds_read_b128 v[16:19], v160 offset:0
    ds_read_b128 v[20:23], v161 offset:0
    ds_read_b128 v[24:27], v160 offset:128
    ds_read_b128 v[28:31], v161 offset:128
    ds_read_b128 v[32:35], v160 offset:256
    ds_read_b128 v[36:39], v161 offset:256
    s_add_u32 s21, s21, 6144
    s_cmp_eq_u32 s21, 36864
    s_cselect_b32 s21, 0, s21
    s_waitcnt lgkmcnt(0)
    s_cmp_eq_u32 s68, 0
    s_cbranch_scc1 .rp_21
    s_sub_u32 s68, s68, 1
    s_add_u32 s28, s23, s22
    v_lshlrev_b32 v58, 4, v1
    v_add_u32 v58, s28, v58
    ds_write_b128 v58, v[200:203] offset:0
    ds_write_b128 v58, v[204:207] offset:1024
    ds_write_b128 v58, v[208:211] offset:2048
    ds_write_b128 v58, v[212:215] offset:3072
    ds_write_b128 v58, v[216:219] offset:4096
    ds_write_b128 v58, v[220:223] offset:5120
    s_add_u32 s22, s22, 6144
    s_cmp_eq_u32 s22, 36864
    s_cselect_b32 s22, 0, s22
    s_branch .rpd_22
.rp_21:
    s_cmp_lt_u32 s61, 1024
    s_cselect_b32 s4, s16, s18
    s_cselect_b32 s5, s17, s19
    s_add_u32 s29, s64, 12288
    s_add_u32 m0, s23, s22
    s_add_u32 s30, s29, 3072
    buffer_load_dwordx4 v2, s[4:7], s29 offen offset:0 nt lds
    buffer_load_dwordx4 v3, s[4:7], s29 offen offset:1024 nt lds
    buffer_load_dwordx4 v4, s[4:7], s29 offen offset:2048 nt lds
    s_add_u32 m0, m0, 3072
    s_nop 0
    buffer_load_dwordx4 v2, s[4:7], s30 offen offset:0 nt lds
    buffer_load_dwordx4 v3, s[4:7], s30 offen offset:1024 nt lds
    buffer_load_dwordx4 v4, s[4:7], s30 offen offset:2048 nt lds
    s_add_u32 s22, s22, 6144
    s_cmp_eq_u32 s22, 36864
    s_cselect_b32 s22, 0, s22
.rpd_22:
    v_mfma_f32_16x16x32_bf16 v[40:43], v[64:67], v[16:19], 0
    v_mfma_f32_16x16x32_bf16 v[40:43], v[68:71], v[20:23], v[40:43]
    v_mfma_f32_16x16x32_bf16 v[40:43], v[72:75], v[24:27], v[40:43]
    v_mfma_f32_16x16x32_bf16 v[40:43], v[76:79], v[28:31], v[40:43]
    v_mfma_f32_16x16x32_bf16 v[40:43], v[80:83], v[32:35], v[40:43]
    v_mfma_f32_16x16x32_bf16 v[40:43], v[84:87], v[36:39], v[40:43]
    s_waitcnt vmcnt(30)
    v_add_u32 v160, s21, v10
    v_add_u32 v161, s21, v11
    ds_read_b128 v[16:19], v160 offset:0
    ds_read_b128 v[20:23], v161 offset:0
    ds_read_b128 v[24:27], v160 offset:128
    ds_read_b128 v[28:31], v161 offset:128
    ds_read_b128 v[32:35], v160 offset:256
    ds_read_b128 v[36:39], v161 offset:256
    s_add_u32 s21, s21, 6144
    s_cmp_eq_u32 s21, 36864
    s_cselect_b32 s21, 0, s21
    s_waitcnt lgkmcnt(0)
    s_cmp_eq_u32 s68, 0
    s_cbranch_scc1 .rp_23
    s_sub_u32 s68, s68, 1
    s_add_u32 s28, s23, s22
    v_lshlrev_b32 v58, 4, v1
    v_add_u32 v58, s28, v58
    ds_write_b128 v58, v[224:227] offset:0
    ds_write_b128 v58, v[228:231] offset:1024
    ds_write_b128 v58, v[232:235] offset:2048
    ds_write_b128 v58, v[236:239] offset:3072
    ds_write_b128 v58, v[240:243] offset:4096
    ds_write_b128 v58, v[244:247] offset:5120
    s_add_u32 s22, s22, 6144
    s_cmp_eq_u32 s22, 36864
    s_cselect_b32 s22, 0, s22
    s_branch .rpd_24
.rp_23:
    s_cmp_lt_u32 s61, 1024
    s_cselect_b32 s4, s16, s18
    s_cselect_b32 s5, s17, s19
    s_add_u32 s29, s64, 18432
    s_add_u32 m0, s23, s22
    s_add_u32 s30, s29, 3072
    buffer_load_dwordx4 v2, s[4:7], s29 offen offset:0 nt lds
    buffer_load_dwordx4 v3, s[4:7], s29 offen offset:1024 nt lds
    buffer_load_dwordx4 v4, s[4:7], s29 offen offset:2048 nt lds
    s_add_u32 m0, m0, 3072
    s_nop 0
    buffer_load_dwordx4 v2, s[4:7], s30 offen offset:0 nt lds
    buffer_load_dwordx4 v3, s[4:7], s30 offen offset:1024 nt lds
    buffer_load_dwordx4 v4, s[4:7], s30 offen offset:2048 nt lds
    s_add_u32 s22, s22, 6144
    s_cmp_eq_u32 s22, 36864
    s_cselect_b32 s22, 0, s22
.rpd_24:
    v_mfma_f32_16x16x32_bf16 v[40:43], v[88:91], v[16:19], v[40:43]
    v_mfma_f32_16x16x32_bf16 v[40:43], v[92:95], v[20:23], v[40:43]
    v_mfma_f32_16x16x32_bf16 v[40:43], v[96:99], v[24:27], v[40:43]
    v_mfma_f32_16x16x32_bf16 v[40:43], v[100:103], v[28:31], v[40:43]
    v_mfma_f32_16x16x32_bf16 v[40:43], v[104:107], v[32:35], v[40:43]
    v_mfma_f32_16x16x32_bf16 v[40:43], v[108:111], v[36:39], v[40:43]
    s_waitcnt vmcnt(30)
    v_add_u32 v160, s21, v10
    v_add_u32 v161, s21, v11
    ds_read_b128 v[16:19], v160 offset:0
    ds_read_b128 v[20:23], v161 offset:0
    ds_read_b128 v[24:27], v160 offset:128
    ds_read_b128 v[28:31], v161 offset:128
    ds_read_b128 v[32:35], v160 offset:256
    ds_read_b128 v[36:39], v161 offset:256
    s_add_u32 s21, s21, 6144
    s_cmp_eq_u32 s21, 36864
    s_cselect_b32 s21, 0, s21
    s_waitcnt lgkmcnt(0)
.Lg_top3:
    s_cmp_ge_u32 s44, 2
    s_cbranch_scc1 .Lg_v3
    s_cmp_lt_u32 s45, 7
    s_cbranch_scc1 .Lg_static3
    s_cmp_lg_u32 s49, 0x7fffffff
    s_cbranch_scc1 .Lg_bk3
    v_mov_b32 v62, 162844
.Lg_bs3:
    ds_read_b32 v59, v62
    s_waitcnt lgkmcnt(0)
    v_readfirstlane_b32 s49, v59
    s_nop 0
    s_cmp_eq_u32 s49, 0x7fffffff
    s_cbranch_scc0 .Lg_bk3
    s_sleep 1
    s_branch .Lg_bs3
.Lg_bk3:
    s_cmp_eq_u32 s44, 0
    s_cselect_b32 s28, 2, 2
    s_mul_i32 s28, s28, s49
    s_add_u32 s28, s28, 4
    s_and_b32 s29, s2, 1
    s_cmp_eq_u32 s29, 0
    s_cselect_b32 s29, 0, s28
    s_cselect_b32 s30, s28, 8
    s_sub_u32 s28, s45, 7
    s_lshl_b32 s28, s28, 2
    s_add_u32 s28, s28, s20
    s_add_u32 s28, s28, s29
    s_cmp_ge_u32 s28, s30
    s_cbranch_scc1 .Lg_next3
    s_add_u32 s45, s45, 1
    s_lshr_b32 s29, s26, 1
    s_lshl_b32 s29, s29, 3
    s_add_u32 s28, s28, s29
    s_add_u32 s28, s28, 448
    s_branch .Lg_rec3
.Lg_next3:
    s_add_u32 s44, s44, 1
    s_mov_b32 s45, 0
    s_branch .Lg_top3
.Lg_static3:
    s_mul_i32 s28, s27, 7
    s_add_u32 s28, s28, s45
    s_add_u32 s45, s45, 1
.Lg_rec3:
    s_cmp_eq_u32 s44, 0
    s_cselect_b32 s29, s47, s48
    s_lshl_b32 s30, s44, 4
    s_add_u32 s30, s30, s29
    s_add_u32 s29, s29, 1
    s_cmp_eq_u32 s44, 0
    s_cselect_b32 s47, s29, s47
    s_cselect_b32 s48, s48, s29
    s_mov_b32 m0, s30
    s_nop 0
    v_writelane_b32 v63, s28, m0
    s_branch .Lg_emit3
.Lg_v3:
    s_cmp_ge_u32 s44, 4
    s_cbranch_scc1 .Lg_end3
    s_cmp_eq_u32 s44, 2
    s_cselect_b32 s29, s47, s48
    s_cmp_lt_u32 s45, s29
    s_cbranch_scc1 .Lg_rep3
    s_add_u32 s44, s44, 1
    s_mov_b32 s45, 0
    s_branch .Lg_v3
.Lg_rep3:
    s_sub_u32 s30, s44, 2
    s_lshl_b32 s30, s30, 4
    s_add_u32 s30, s30, s45
    s_add_u32 s45, s45, 1
    s_nop 1
    v_readlane_b32 s28, v63, s30
.Lg_emit3:
    s_lshl_b32 s29, s44, 9
    s_or_b32 s62, s29, s28
    s_and_b32 s29, s44, 1
    s_mul_i32 s29, s29, 12582912
    s_mul_i32 s28, s28, 24576
    s_add_u32 s28, s28, s29
    s_add_u32 s65, s28, s24
    s_branch .Lg_out3
.Lg_end3:
    s_mov_b32 s62, -1
    s_mov_b32 s65, 0x80000000
.Lg_out3:
    s_cmp_lt_u32 s62, 1024
    s_cselect_b32 s4, s16, s18
    s_cselect_b32 s5, s17, s19
    s_add_u32 s29, s65, 0
    s_add_u32 m0, s23, s22
    s_add_u32 s30, s29, 3072
    buffer_load_dwordx4 v2, s[4:7], s29 offen offset:0 nt lds
    buffer_load_dwordx4 v3, s[4:7], s29 offen offset:1024 nt lds
    buffer_load_dwordx4 v4, s[4:7], s29 offen offset:2048 nt lds
    s_add_u32 m0, m0, 3072
    s_nop 0
    buffer_load_dwordx4 v2, s[4:7], s30 offen offset:0 nt lds
    buffer_load_dwordx4 v3, s[4:7], s30 offen offset:1024 nt lds
    buffer_load_dwordx4 v4, s[4:7], s30 offen offset:2048 nt lds
    s_add_u32 s22, s22, 6144
    s_cmp_eq_u32 s22, 36864
    s_cselect_b32 s22, 0, s22
    v_mfma_f32_16x16x32_bf16 v[40:43], v[112:115], v[16:19], v[40:43]
    v_mfma_f32_16x16x32_bf16 v[40:43], v[116:119], v[20:23], v[40:43]
    v_mfma_f32_16x16x32_bf16 v[40:43], v[120:123], v[24:27], v[40:43]
    v_mfma_f32_16x16x32_bf16 v[40:43], v[124:127], v[28:31], v[40:43]
    v_mfma_f32_16x16x32_bf16 v[40:43], v[128:131], v[32:35], v[40:43]
    v_mfma_f32_16x16x32_bf16 v[40:43], v[132:135], v[36:39], v[40:43]
    s_waitcnt vmcnt(30)
    v_add_u32 v160, s21, v10
    v_add_u32 v161, s21, v11
    ds_read_b128 v[16:19], v160 offset:0
    ds_read_b128 v[20:23], v161 offset:0
    ds_read_b128 v[24:27], v160 offset:128
    ds_read_b128 v[28:31], v161 offset:128
    ds_read_b128 v[32:35], v160 offset:256
    ds_read_b128 v[36:39], v161 offset:256
    s_add_u32 s21, s21, 6144
    s_cmp_eq_u32 s21, 36864
    s_cselect_b32 s21, 0, s21
    s_waitcnt lgkmcnt(0)
    s_cmp_lt_u32 s62, 1024
    s_cselect_b32 s4, s16, s18
    s_cselect_b32 s5, s17, s19
    s_add_u32 s29, s65, 6144
    s_add_u32 m0, s23, s22
    s_add_u32 s30, s29, 3072
    buffer_load_dwordx4 v2, s[4:7], s29 offen offset:0 nt lds
    buffer_load_dwordx4 v3, s[4:7], s29 offen offset:1024 nt lds
    buffer_load_dwordx4 v4, s[4:7], s29 offen offset:2048 nt lds
    s_add_u32 m0, m0, 3072
    s_nop 0
    buffer_load_dwordx4 v2, s[4:7], s30 offen offset:0 nt lds
    buffer_load_dwordx4 v3, s[4:7], s30 offen offset:1024 nt lds
    buffer_load_dwordx4 v4, s[4:7], s30 offen offset:2048 nt lds
    s_add_u32 s22, s22, 6144
    s_cmp_eq_u32 s22, 36864
    s_cselect_b32 s22, 0, s22
    v_mfma_f32_16x16x32_bf16 v[40:43], v[136:139], v[16:19], v[40:43]
    v_mfma_f32_16x16x32_bf16 v[40:43], v[140:143], v[20:23], v[40:43]
    v_mfma_f32_16x16x32_bf16 v[40:43], v[144:147], v[24:27], v[40:43]
    v_mfma_f32_16x16x32_bf16 v[40:43], v[148:151], v[28:31], v[40:43]
    v_mfma_f32_16x16x32_bf16 v[40:43], v[152:155], v[32:35], v[40:43]
    v_mfma_f32_16x16x32_bf16 v[40:43], v[156:159], v[36:39], v[40:43]
    s_nop 7
    s_nop 1
    v_cvt_pk_bf16_f32 v44, v40, v40
    v_lshlrev_b32 v44, 16, v44
    v_mul_f32 v44, 1033096506, v44
    v_cvt_pk_bf16_f32 v44, v44, v44
    ds_write_b16 v55, v44
    v_lshlrev_b32 v44, 16, v44
    v_max_f32 v46, v54, v44
    v_sub_f32 v47, v54, v46
    v_sub_f32 v48, v44, v46
    v_mul_f32 v47, 1069066811, v47
    v_mul_f32 v48, 1069066811, v48
    v_exp_f32 v47, v47
    v_exp_f32 v48, v48
    v_mov_b32 v54, v46
    v_fma_f32 v45, v45, v47, v48
    v_add_u32 v55, 128, v55
    s_mov_b32 s60, s61
    s_mov_b32 s63, s64
    s_mov_b32 s61, s62
    s_mov_b32 s64, s65
    s_add_u32 s66, s66, 1
    s_lshr_b32 s28, s60, 9
    s_cmp_eq_u32 s28, 0
    s_cbranch_scc1 .kloop_20
    v_mov_b32 v44, v54
    s_nop 1
    v_max_f32_dpp v44, v44, v44 quad_perm:[1,0,3,2] row_mask:0xf bank_mask:0xf
    s_nop 1
    v_max_f32_dpp v44, v44, v44 quad_perm:[2,3,0,1] row_mask:0xf bank_mask:0xf
    s_nop 1
    v_max_f32_dpp v44, v44, v44 row_half_mirror row_mask:0xf bank_mask:0xf
    s_nop 1
    v_max_f32_dpp v44, v44, v44 row_mirror row_mask:0xf bank_mask:0xf
    s_nop 1
    v_readlane_b32 s40, v44, 0
    v_readlane_b32 s41, v44, 16
    v_readlane_b32 s42, v44, 32
    v_readlane_b32 s43, v44, 48
    s_nop 1
    v_mov_b32 v44, s40
    v_max_f32 v44, s41, v44
    v_max_f32 v44, s42, v44
    v_max_f32 v44, s43, v44
    v_sub_f32 v47, v54, v44
    v_mul_f32 v47, 1069066811, v47
    v_exp_f32 v47, v47
    s_nop 0
    v_mul_f32 v45, v45, v47
    s_nop 1
    v_add_f32_dpp v45, v45, v45 quad_perm:[1,0,3,2] row_mask:0xf bank_mask:0xf
    s_nop 1
    v_add_f32_dpp v45, v45, v45 quad_perm:[2,3,0,1] row_mask:0xf bank_mask:0xf
    s_nop 1
    v_add_f32_dpp v45, v45, v45 row_half_mirror row_mask:0xf bank_mask:0xf
    s_nop 1
    v_add_f32_dpp v45, v45, v45 row_mirror row_mask:0xf bank_mask:0xf
    s_nop 1
    v_readlane_b32 s40, v45, 0
    v_readlane_b32 s41, v45, 16
    v_readlane_b32 s42, v45, 32
    v_readlane_b32 s43, v45, 48
    s_nop 1
    v_mov_b32 v45, s40
    v_add_f32 v45, s41, v45
    v_add_f32 v45, s42, v45
    v_add_f32 v45, s43, v45
    v_mov_b32 v46, 0x7fc00000
    v_cmp_eq_u32 vcc, -1, v44
    s_nop 1
    v_cndmask_b32 v44, v44, v46, vcc
    v_mov_b32 v46, 0x7fc00000
    v_cmp_eq_u32 vcc, -1, v45
    s_nop 1
    v_cndmask_b32 v45, v45, v46, vcc
    s_lshl_b32 s35, s25, 10
    s_lshl_b32 s36, s27, 3
    s_add_u32 s35, s35, s36
    s_add_u32 s35, s35, 32768
    s_mov_b64 exec, 1
    buffer_store_dwordx2 v[44:45], v52, s[8:11], s35 offen sc1
    s_mov_b64 exec, -1
    v_cmp_eq_u32 vcc, 0, v7
    s_nop 1
    v_cndmask_b32 v64, 0, v176, vcc
    v_cndmask_b32 v65, 0, v177, vcc
    v_cndmask_b32 v66, 0, v178, vcc
    v_cndmask_b32 v67, 0, v179, vcc
    v_cndmask_b32 v68, 0, v180, vcc
    v_cndmask_b32 v69, 0, v181, vcc
    v_cndmask_b32 v70, 0, v182, vcc
    v_cndmask_b32 v71, 0, v183, vcc
    v_cndmask_b32 v72, 0, v184, vcc
    v_cndmask_b32 v73, 0, v185, vcc
    v_cndmask_b32 v74, 0, v186, vcc
    v_cndmask_b32 v75, 0, v187, vcc
    v_cndmask_b32 v76, 0, v188, vcc
    v_cndmask_b32 v77, 0, v189, vcc
    v_cndmask_b32 v78, 0, v190, vcc
    v_cndmask_b32 v79, 0, v191, vcc
    v_cndmask_b32 v80, 0, v192, vcc
    v_cndmask_b32 v81, 0, v193, vcc
    v_cndmask_b32 v82, 0, v194, vcc
    v_cndmask_b32 v83, 0, v195, vcc
    v_cndmask_b32 v84, 0, v196, vcc
    v_cndmask_b32 v85, 0, v197, vcc
    v_cndmask_b32 v86, 0, v198, vcc
    v_cndmask_b32 v87, 0, v199, vcc
    v_cmp_eq_u32 vcc, 4, v7
    s_nop 1
    v_cndmask_b32 v88, 0, v176, vcc
    v_cndmask_b32 v89, 0, v177, vcc
    v_cndmask_b32 v90, 0, v178, vcc
    v_cndmask_b32 v91, 0, v179, vcc
    v_cndmask_b32 v92, 0, v180, vcc
    v_cndmask_b32 v93, 0, v181, vcc
    v_cndmask_b32 v94, 0, v182, vcc
    v_cndmask_b32 v95, 0, v183, vcc
    v_cndmask_b32 v96, 0, v184, vcc
    v_cndmask_b32 v97, 0, v185, vcc
    v_cndmask_b32 v98, 0, v186, vcc
    v_cndmask_b32 v99, 0, v187, vcc
    v_cndmask_b32 v100, 0, v188, vcc
    v_cndmask_b32 v101, 0, v189, vcc
    v_cndmask_b32 v102, 0, v190, vcc
    v_cndmask_b32 v103, 0, v191, vcc
    v_cndmask_b32 v104, 0, v192, vcc
    v_cndmask_b32 v105, 0, v193, vcc
    v_cndmask_b32 v106, 0, v194, vcc
    v_cndmask_b32 v107, 0, v195, vcc
    v_cndmask_b32 v108, 0, v196, vcc
    v_cndmask_b32 v109, 0, v197, vcc
    v_cndmask_b32 v110, 0, v198, vcc
    v_cndmask_b32 v111, 0, v199, vcc
    v_cmp_eq_u32 vcc, 8, v7
    s_nop 1
    v_cndmask_b32 v112, 0, v176, vcc
    v_cndmask_b32 v113, 0, v177, vcc
    v_cndmask_b32 v114, 0, v178, vcc
    v_cndmask_b32 v115, 0, v179, vcc
    v_cndmask_b32 v116, 0, v180, vcc
    v_cndmask_b32 v117, 0, v181, vcc
    v_cndmask_b32 v118, 0, v182, vcc
    v_cndmask_b32 v119, 0, v183, vcc
    v_cndmask_b32 v120, 0, v184, vcc
    v_cndmask_b32 v121, 0, v185, vcc
    v_cndmask_b32 v122, 0, v186, vcc
    v_cndmask_b32 v123, 0, v187, vcc
    v_cndmask_b32 v124, 0, v188, vcc
    v_cndmask_b32 v125, 0, v189, vcc
    v_cndmask_b32 v126, 0, v190, vcc
    v_cndmask_b32 v127, 0, v191, vcc
    v_cndmask_b32 v128, 0, v192, vcc
    v_cndmask_b32 v129, 0, v193, vcc
    v_cndmask_b32 v130, 0, v194, vcc
    v_cndmask_b32 v131, 0, v195, vcc
    v_cndmask_b32 v132, 0, v196, vcc
    v_cndmask_b32 v133, 0, v197, vcc
    v_cndmask_b32 v134, 0, v198, vcc
    v_cndmask_b32 v135, 0, v199, vcc
    v_cmp_eq_u32 vcc, 12, v7
    s_nop 1
    v_cndmask_b32 v136, 0, v176, vcc
    v_cndmask_b32 v137, 0, v177, vcc
    v_cndmask_b32 v138, 0, v178, vcc
    v_cndmask_b32 v139, 0, v179, vcc
    v_cndmask_b32 v140, 0, v180, vcc
    v_cndmask_b32 v141, 0, v181, vcc
    v_cndmask_b32 v142, 0, v182, vcc
    v_cndmask_b32 v143, 0, v183, vcc
    v_cndmask_b32 v144, 0, v184, vcc
    v_cndmask_b32 v145, 0, v185, vcc
    v_cndmask_b32 v146, 0, v186, vcc
    v_cndmask_b32 v147, 0, v187, vcc
    v_cndmask_b32 v148, 0, v188, vcc
    v_cndmask_b32 v149, 0, v189, vcc
    v_cndmask_b32 v150, 0, v190, vcc
    v_cndmask_b32 v151, 0, v191, vcc
    v_cndmask_b32 v152, 0, v192, vcc
    v_cndmask_b32 v153, 0, v193, vcc
    v_cndmask_b32 v154, 0, v194, vcc
    v_cndmask_b32 v155, 0, v195, vcc
    v_cndmask_b32 v156, 0, v196, vcc
    v_cndmask_b32 v157, 0, v197, vcc
    v_cndmask_b32 v158, 0, v198, vcc
    v_cndmask_b32 v159, 0, v199, vcc
    v_mov_b32 v54, 0xff800000
    v_mov_b32 v45, 0
    v_lshlrev_b32 v55, 1, v1
    s_add_u32 s34, s32, 7168
    v_add_u32 v55, s34, v55
    s_mov_b32 s66, 0
.kloop_25:
    s_waitcnt vmcnt(30)
    v_add_u32 v160, s21, v10
    v_add_u32 v161, s21, v11
    ds_read_b128 v[16:19], v160 offset:0
    ds_read_b128 v[20:23], v161 offset:0
    ds_read_b128 v[24:27], v160 offset:128
    ds_read_b128 v[28:31], v161 offset:128
    ds_read_b128 v[32:35], v160 offset:256
    ds_read_b128 v[36:39], v161 offset:256
    s_add_u32 s21, s21, 6144
    s_cmp_eq_u32 s21, 36864
    s_cselect_b32 s21, 0, s21
    s_waitcnt lgkmcnt(0)
    s_cmp_lt_u32 s61, 1024
    s_cselect_b32 s4, s16, s18
    s_cselect_b32 s5, s17, s19
    s_add_u32 s29, s64, 12288
    s_add_u32 m0, s23, s22
    s_add_u32 s30, s29, 3072
    buffer_load_dwordx4 v2, s[4:7], s29 offen offset:0 nt lds
    buffer_load_dwordx4 v3, s[4:7], s29 offen offset:1024 nt lds
    buffer_load_dwordx4 v4, s[4:7], s29 offen offset:2048 nt lds
    s_add_u32 m0, m0, 3072
    s_nop 0
    buffer_load_dwordx4 v2, s[4:7], s30 offen offset:0 nt lds
    buffer_load_dwordx4 v3, s[4:7], s30 offen offset:1024 nt lds
    buffer_load_dwordx4 v4, s[4:7], s30 offen offset:2048 nt lds
    s_add_u32 s22, s22, 6144
    s_cmp_eq_u32 s22, 36864
    s_cselect_b32 s22, 0, s22
    v_mfma_f32_16x16x32_bf16 v[40:43], v[64:67], v[16:19], 0
    v_mfma_f32_16x16x32_bf16 v[40:43], v[68:71], v[20:23], v[40:43]
    v_mfma_f32_16x16x32_bf16 v[40:43], v[72:75], v[24:27], v[40:43]
    v_mfma_f32_16x16x32_bf16 v[40:43], v[76:79], v[28:31], v[40:43]
    v_mfma_f32_16x16x32_bf16 v[40:43], v[80:83], v[32:35], v[40:43]
    v_mfma_f32_16x16x32_bf16 v[40:43], v[84:87], v[36:39], v[40:43]
    s_waitcnt vmcnt(30)
    v_add_u32 v160, s21, v10
    v_add_u32 v161, s21, v11
    ds_read_b128 v[16:19], v160 offset:0
    ds_read_b128 v[20:23], v161 offset:0
    ds_read_b128 v[24:27], v160 offset:128
    ds_read_b128 v[28:31], v161 offset:128
    ds_read_b128 v[32:35], v160 offset:256
    ds_read_b128 v[36:39], v161 offset:256
    s_add_u32 s21, s21, 6144
    s_cmp_eq_u32 s21, 36864
    s_cselect_b32 s21, 0, s21
    s_waitcnt lgkmcnt(0)
    s_cmp_lt_u32 s61, 1024
    s_cselect_b32 s4, s16, s18
    s_cselect_b32 s5, s17, s19
    s_add_u32 s29, s64, 18432
    s_add_u32 m0, s23, s22
    s_add_u32 s30, s29, 3072
    buffer_load_dwordx4 v2, s[4:7], s29 offen offset:0 nt lds
    buffer_load_dwordx4 v3, s[4:7], s29 offen offset:1024 nt lds
    buffer_load_dwordx4 v4, s[4:7], s29 offen offset:2048 nt lds
    s_add_u32 m0, m0, 3072
    s_nop 0
    buffer_load_dwordx4 v2, s[4:7], s30 offen offset:0 nt lds
    buffer_load_dwordx4 v3, s[4:7], s30 offen offset:1024 nt lds
    buffer_load_dwordx4 v4, s[4:7], s30 offen offset:2048 nt lds
    s_add_u32 s22, s22, 6144
    s_cmp_eq_u32 s22, 36864
    s_cselect_b32 s22, 0, s22
    v_mfma_f32_16x16x32_bf16 v[40:43], v[88:91], v[16:19], v[40:43]
    v_mfma_f32_16x16x32_bf16 v[40:43], v[92:95], v[20:23], v[40:43]
    v_mfma_f32_16x16x32_bf16 v[40:43], v[96:99], v[24:27], v[40:43]
    v_mfma_f32_16x16x32_bf16 v[40:43], v[100:103], v[28:31], v[40:43]
    v_mfma_f32_16x16x32_bf16 v[40:43], v[104:107], v[32:35], v[40:43]
    v_mfma_f32_16x16x32_bf16 v[40:43], v[108:111], v[36:39], v[40:43]
    s_waitcnt vmcnt(30)
    v_add_u32 v160, s21, v10
    v_add_u32 v161, s21, v11
    ds_read_b128 v[16:19], v160 offset:0
    ds_read_b128 v[20:23], v161 offset:0
    ds_read_b128 v[24:27], v160 offset:128
    ds_read_b128 v[28:31], v161 offset:128
    ds_read_b128 v[32:35], v160 offset:256
    ds_read_b128 v[36:39], v161 offset:256
    s_add_u32 s21, s21, 6144
    s_cmp_eq_u32 s21, 36864
    s_cselect_b32 s21, 0, s21
    s_waitcnt lgkmcnt(0)
.Lg_top4:
    s_cmp_ge_u32 s44, 2
    s_cbranch_scc1 .Lg_v4
    s_cmp_lt_u32 s45, 7
    s_cbranch_scc1 .Lg_static4
    s_cmp_lg_u32 s49, 0x7fffffff
    s_cbranch_scc1 .Lg_bk4
    v_mov_b32 v62, 162844
.Lg_bs4:
    ds_read_b32 v59, v62
    s_waitcnt lgkmcnt(0)
    v_readfirstlane_b32 s49, v59
    s_nop 0
    s_cmp_eq_u32 s49, 0x7fffffff
    s_cbranch_scc0 .Lg_bk4
    s_sleep 1
    s_branch .Lg_bs4
.Lg_bk4:
    s_cmp_eq_u32 s44, 0
    s_cselect_b32 s28, 2, 2
    s_mul_i32 s28, s28, s49
    s_add_u32 s28, s28, 4
    s_and_b32 s29, s2, 1
    s_cmp_eq_u32 s29, 0
    s_cselect_b32 s29, 0, s28
    s_cselect_b32 s30, s28, 8
    s_sub_u32 s28, s45, 7
    s_lshl_b32 s28, s28, 2
    s_add_u32 s28, s28, s20
    s_add_u32 s28, s28, s29
    s_cmp_ge_u32 s28, s30
    s_cbranch_scc1 .Lg_next4
    s_add_u32 s45, s45, 1
    s_lshr_b32 s29, s26, 1
    s_lshl_b32 s29, s29, 3
    s_add_u32 s28, s28, s29
    s_add_u32 s28, s28, 448
    s_branch .Lg_rec4
.Lg_next4:
    s_add_u32 s44, s44, 1
    s_mov_b32 s45, 0
    s_branch .Lg_top4
.Lg_static4:
    s_mul_i32 s28, s27, 7
    s_add_u32 s28, s28, s45
    s_add_u32 s45, s45, 1
.Lg_rec4:
    s_cmp_eq_u32 s44, 0
    s_cselect_b32 s29, s47, s48
    s_lshl_b32 s30, s44, 4
    s_add_u32 s30, s30, s29
    s_add_u32 s29, s29, 1
    s_cmp_eq_u32 s44, 0
    s_cselect_b32 s47, s29, s47
    s_cselect_b32 s48, s48, s29
    s_mov_b32 m0, s30
    s_nop 0
    v_writelane_b32 v63, s28, m0
    s_branch .Lg_emit4
.Lg_v4:
    s_cmp_ge_u32 s44, 4
    s_cbranch_scc1 .Lg_end4
    s_cmp_eq_u32 s44, 2
    s_cselect_b32 s29, s47, s48
    s_cmp_lt_u32 s45, s29
    s_cbranch_scc1 .Lg_rep4
    s_add_u32 s44, s44, 1
    s_mov_b32 s45, 0
    s_branch .Lg_v4
.Lg_rep4:
    s_sub_u32 s30, s44, 2
    s_lshl_b32 s30, s30, 4
    s_add_u32 s30, s30, s45
    s_add_u32 s45, s45, 1
    s_nop 1
    v_readlane_b32 s28, v63, s30
.Lg_emit4:
    s_lshl_b32 s29, s44, 9
    s_or_b32 s62, s29, s28
    s_and_b32 s29, s44, 1
    s_mul_i32 s29, s29, 12582912
    s_mul_i32 s28, s28, 24576
    s_add_u32 s28, s28, s29
    s_add_u32 s65, s28, s24
    s_branch .Lg_out4
.Lg_end4:
    s_mov_b32 s62, -1
    s_mov_b32 s65, 0x80000000
.Lg_out4:
    s_cmp_lt_u32 s62, 1024
    s_cselect_b32 s4, s16, s18
    s_cselect_b32 s5, s17, s19
    s_add_u32 s29, s65, 0
    s_add_u32 m0, s23, s22
    s_add_u32 s30, s29, 3072
    buffer_load_dwordx4 v2, s[4:7], s29 offen offset:0 nt lds
    buffer_load_dwordx4 v3, s[4:7], s29 offen offset:1024 nt lds
    buffer_load_dwordx4 v4, s[4:7], s29 offen offset:2048 nt lds
    s_add_u32 m0, m0, 3072
    s_nop 0
    buffer_load_dwordx4 v2, s[4:7], s30 offen offset:0 nt lds
    buffer_load_dwordx4 v3, s[4:7], s30 offen offset:1024 nt lds
    buffer_load_dwordx4 v4, s[4:7], s30 offen offset:2048 nt lds
    s_add_u32 s22, s22, 6144
    s_cmp_eq_u32 s22, 36864
    s_cselect_b32 s22, 0, s22
    v_mfma_f32_16x16x32_bf16 v[40:43], v[112:115], v[16:19], v[40:43]
    v_mfma_f32_16x16x32_bf16 v[40:43], v[116:119], v[20:23], v[40:43]
    v_mfma_f32_16x16x32_bf16 v[40:43], v[120:123], v[24:27], v[40:43]
    v_mfma_f32_16x16x32_bf16 v[40:43], v[124:127], v[28:31], v[40:43]
    v_mfma_f32_16x16x32_bf16 v[40:43], v[128:131], v[32:35], v[40:43]
    v_mfma_f32_16x16x32_bf16 v[40:43], v[132:135], v[36:39], v[40:43]
    s_waitcnt vmcnt(30)
    v_add_u32 v160, s21, v10
    v_add_u32 v161, s21, v11
    ds_read_b128 v[16:19], v160 offset:0
    ds_read_b128 v[20:23], v161 offset:0
    ds_read_b128 v[24:27], v160 offset:128
    ds_read_b128 v[28:31], v161 offset:128
    ds_read_b128 v[32:35], v160 offset:256
    ds_read_b128 v[36:39], v161 offset:256
    s_add_u32 s21, s21, 6144
    s_cmp_eq_u32 s21, 36864
    s_cselect_b32 s21, 0, s21
    s_waitcnt lgkmcnt(0)
    s_cmp_lt_u32 s62, 1024
    s_cselect_b32 s4, s16, s18
    s_cselect_b32 s5, s17, s19
    s_add_u32 s29, s65, 6144
    s_add_u32 m0, s23, s22
    s_add_u32 s30, s29, 3072
    buffer_load_dwordx4 v2, s[4:7], s29 offen offset:0 nt lds
    buffer_load_dwordx4 v3, s[4:7], s29 offen offset:1024 nt lds
    buffer_load_dwordx4 v4, s[4:7], s29 offen offset:2048 nt lds
    s_add_u32 m0, m0, 3072
    s_nop 0
    buffer_load_dwordx4 v2, s[4:7], s30 offen offset:0 nt lds
    buffer_load_dwordx4 v3, s[4:7], s30 offen offset:1024 nt lds
    buffer_load_dwordx4 v4, s[4:7], s30 offen offset:2048 nt lds
    s_add_u32 s22, s22, 6144
    s_cmp_eq_u32 s22, 36864
    s_cselect_b32 s22, 0, s22
    v_mfma_f32_16x16x32_bf16 v[40:43], v[136:139], v[16:19], v[40:43]
    v_mfma_f32_16x16x32_bf16 v[40:43], v[140:143], v[20:23], v[40:43]
    v_mfma_f32_16x16x32_bf16 v[40:43], v[144:147], v[24:27], v[40:43]
    v_mfma_f32_16x16x32_bf16 v[40:43], v[148:151], v[28:31], v[40:43]
    v_mfma_f32_16x16x32_bf16 v[40:43], v[152:155], v[32:35], v[40:43]
    v_mfma_f32_16x16x32_bf16 v[40:43], v[156:159], v[36:39], v[40:43]
    s_cmp_lg_u32 s66, 4
    s_cbranch_scc1 .skip_26
    buffer_load_dword v57, v52, s[12:15], 0 offen offset:128 sc1
    s_lshl_b32 s35, s25, 10
    s_add_u32 s35, s35, 32768
    v_lshlrev_b32 v56, 3, v1
    buffer_load_dwordx2 v[50:51], v56, s[8:11], s35 offen sc1
.skip_26:
    s_nop 7
    s_nop 1
    v_cvt_pk_bf16_f32 v44, v40, v40
    v_lshlrev_b32 v44, 16, v44
    v_mul_f32 v44, 1033096506, v44
    v_cvt_pk_bf16_f32 v44, v44, v44
    ds_write_b16 v55, v44
    v_lshlrev_b32 v44, 16, v44
    v_max_f32 v46, v54, v44
    v_sub_f32 v47, v54, v46
    v_sub_f32 v48, v44, v46
    v_mul_f32 v47, 1069066811, v47
    v_mul_f32 v48, 1069066811, v48
    v_exp_f32 v47, v47
    v_exp_f32 v48, v48
    v_mov_b32 v54, v46
    v_fma_f32 v45, v45, v47, v48
    v_add_u32 v55, 128, v55
    s_mov_b32 s60, s61
    s_mov_b32 s63, s64
    s_mov_b32 s61, s62
    s_mov_b32 s64, s65
    s_add_u32 s66, s66, 1
    s_lshr_b32 s28, s60, 9
    s_cmp_eq_u32 s28, 1
    s_cbranch_scc1 .kloop_25
    v_mov_b32 v44, v54
    s_nop 1
    v_max_f32_dpp v44, v44, v44 quad_perm:[1,0,3,2] row_mask:0xf bank_mask:0xf
    s_nop 1
    v_max_f32_dpp v44, v44, v44 quad_perm:[2,3,0,1] row_mask:0xf bank_mask:0xf
    s_nop 1
    v_max_f32_dpp v44, v44, v44 row_half_mirror row_mask:0xf bank_mask:0xf
    s_nop 1
    v_max_f32_dpp v44, v44, v44 row_mirror row_mask:0xf bank_mask:0xf
    s_nop 1
    v_readlane_b32 s40, v44, 0
    v_readlane_b32 s41, v44, 16
    v_readlane_b32 s42, v44, 32
    v_readlane_b32 s43, v44, 48
    s_nop 1
    v_mov_b32 v44, s40
    v_max_f32 v44, s41, v44
    v_max_f32 v44, s42, v44
    v_max_f32 v44, s43, v44
    v_sub_f32 v47, v54, v44
    v_mul_f32 v47, 1069066811, v47
    v_exp_f32 v47, v47
    s_nop 0
    v_mul_f32 v45, v45, v47
    s_nop 1
    v_add_f32_dpp v45, v45, v45 quad_perm:[1,0,3,2] row_mask:0xf bank_mask:0xf
    s_nop 1
    v_add_f32_dpp v45, v45, v45 quad_perm:[2,3,0,1] row_mask:0xf bank_mask:0xf
    s_nop 1
    v_add_f32_dpp v45, v45, v45 row_half_mirror row_mask:0xf bank_mask:0xf
    s_nop 1
    v_add_f32_dpp v45, v45, v45 row_mirror row_mask:0xf bank_mask:0xf
    s_nop 1
    v_readlane_b32 s40, v45, 0
    v_readlane_b32 s41, v45, 16
    v_readlane_b32 s42, v45, 32
    v_readlane_b32 s43, v45, 48
    s_nop 1
    v_mov_b32 v45, s40
    v_add_f32 v45, s41, v45
    v_add_f32 v45, s42, v45
    v_add_f32 v45, s43, v45
    v_mov_b32 v46, 0x7fc00000
    v_cmp_eq_u32 vcc, -1, v44
    s_nop 1
    v_cndmask_b32 v44, v44, v46, vcc
    v_mov_b32 v46, 0x7fc00000
    v_cmp_eq_u32 vcc, -1, v45
    s_nop 1
    v_cndmask_b32 v45, v45, v46, vcc
    s_lshl_b32 s35, s25, 10
    s_lshl_b32 s36, s27, 3
    s_add_u32 s35, s35, s36
    s_add_u32 s35, s35, 33280
    s_mov_b64 exec, 1
    buffer_store_dwordx2 v[44:45], v52, s[8:11], s35 offen sc1
    s_mov_b64 exec, -1
    v_cmp_gt_u32 vcc, 256, v57
    s_cbranch_vccnz .mlslow_28
    v_max_u32 v53, v50, v51
    v_cmp_eq_u32 vcc, -1, v53
    s_cbranch_vccz .mlok_27
.mlslow_28:
    s_mov_b32 s39, 0
.pc_29:
    buffer_load_dword v53, v52, s[12:15], 0 offen offset:128 sc1
    s_waitcnt vmcnt(0)
    v_readfirstlane_b32 s38, v53
    s_nop 0
    s_cmp_ge_u32 s38, 256
    s_cbranch_scc1 .pcd_30
    s_add_u32 s39, s39, 1
    s_cmp_gt_u32 s39, 400000
    s_cbranch_scc1 .pcd_30
    s_sleep 1
    s_branch .pc_29
.pcd_30:
    s_mov_b32 s39, 0
.poll_31:
    buffer_load_dword v57, v52, s[12:15], 0 offen offset:128 sc1
    s_lshl_b32 s35, s25, 10
    s_add_u32 s35, s35, 32768
    v_lshlrev_b32 v56, 3, v1
    buffer_load_dwordx2 v[50:51], v56, s[8:11], s35 offen sc1
    s_waitcnt vmcnt(0)
    v_mov_b32 v53, v50
    v_max_u32 v53, v53, v51
    v_cmp_eq_u32 vcc, -1, v53
    s_cbranch_vccz .polld_32
    s_add_u32 s39, s39, 1
    s_cmp_gt_u32 s39, 400000
    s_cbranch_scc1 .polld_32
    s_sleep 1
    s_branch .poll_31
.polld_32:
.mlok_27:
    v_mov_b32 v44, v50
    s_nop 1
    v_max_f32_dpp v44, v44, v44 quad_perm:[1,0,3,2] row_mask:0xf bank_mask:0xf
    s_nop 1
    v_max_f32_dpp v44, v44, v44 quad_perm:[2,3,0,1] row_mask:0xf bank_mask:0xf
    s_nop 1
    v_max_f32_dpp v44, v44, v44 row_half_mirror row_mask:0xf bank_mask:0xf
    s_nop 1
    v_max_f32_dpp v44, v44, v44 row_mirror row_mask:0xf bank_mask:0xf
    s_nop 1
    v_readlane_b32 s40, v44, 0
    v_readlane_b32 s41, v44, 16
    v_readlane_b32 s42, v44, 32
    v_readlane_b32 s43, v44, 48
    s_nop 1
    v_mov_b32 v44, s40
    v_max_f32 v44, s41, v44
    v_max_f32 v44, s42, v44
    v_max_f32 v44, s43, v44
    v_sub_f32 v45, v50, v44
    v_mul_f32 v45, 1069066811, v45
    v_exp_f32 v45, v45
    s_nop 0
    v_mul_f32 v45, v45, v51
    s_nop 1
    v_add_f32_dpp v45, v45, v45 quad_perm:[1,0,3,2] row_mask:0xf bank_mask:0xf
    s_nop 1
    v_add_f32_dpp v45, v45, v45 quad_perm:[2,3,0,1] row_mask:0xf bank_mask:0xf
    s_nop 1
    v_add_f32_dpp v45, v45, v45 row_half_mirror row_mask:0xf bank_mask:0xf
    s_nop 1
    v_add_f32_dpp v45, v45, v45 row_mirror row_mask:0xf bank_mask:0xf
    s_nop 1
    v_readlane_b32 s40, v45, 0
    v_readlane_b32 s41, v45, 16
    v_readlane_b32 s42, v45, 32
    v_readlane_b32 s43, v45, 48
    s_nop 1
    v_mov_b32 v45, s40
    v_add_f32 v45, s41, v45
    v_add_f32 v45, s42, v45
    v_add_f32 v45, s43, v45
    s_add_u32 s34, s32, 0
    v_lshlrev_b32 v55, 1, v1
    v_add_u32 v55, s34, v55
    v_and_b32 v30, 31, v1
    v_bfe_u32 v31, v30, 2, 2
    v_lshlrev_b32 v31, 3, v31
    v_bfe_u32 v32, v30, 4, 1
    v_lshl_add_u32 v31, v32, 2, v31
    v_and_b32 v32, 3, v30
    v_add_u32 v31, v31, v32
    v_lshlrev_b32 v31, 1, v31
    v_lshrrev_b32 v32, 5, v1
    v_lshl_add_u32 v31, v32, 6, v31
    v_add_u32 v31, s34, v31
    s_mov_b32 s66, 0
.ploop_33:
    ds_read_u16 v47, v55
    v_add_u32 v55, 128, v55
    s_waitcnt lgkmcnt(0)
    v_lshlrev_b32 v47, 16, v47
    v_sub_f32 v47, v47, v44
    v_mul_f32 v47, 1069066811, v47
    v_exp_f32 v47, v47
    v_mov_b32 v49, v45
    v_rcp_f32 v56, v49
    s_nop 0
    v_mul_f32 v53, v47, v56
    v_fma_f32 v49, -v53, v49, v47
    v_fma_f32 v47, v49, v56, v53
    v_cvt_pk_bf16_f32 v47, v47, v47
    ds_write_b16 v31, v47
    v_add_u32 v31, 128, v31
    s_add_u32 s66, s66, 1
    s_cmp_lt_u32 s66, s47
    s_cbranch_scc1 .ploop_33
    v_lshlrev_b32 v55, 4, v6
    v_add_u32 v55, s34, v55
    v_mov_b32 v64, 0
    v_mov_b32 v65, 0
    v_mov_b32 v66, 0
    v_mov_b32 v67, 0
    v_mov_b32 v68, 0
    v_mov_b32 v69, 0
    v_mov_b32 v70, 0
    v_mov_b32 v71, 0
    v_mov_b32 v72, 0
    v_mov_b32 v73, 0
    v_mov_b32 v74, 0
    v_mov_b32 v75, 0
    v_mov_b32 v76, 0
    v_mov_b32 v77, 0
    v_mov_b32 v78, 0
    v_mov_b32 v79, 0
    v_mov_b32 v80, 0
    v_mov_b32 v81, 0
    v_mov_b32 v82, 0
    v_mov_b32 v83, 0
    v_mov_b32 v84, 0
    v_mov_b32 v85, 0
    v_mov_b32 v86, 0
    v_mov_b32 v87, 0
    v_mov_b32 v88, 0
    v_mov_b32 v89, 0
    v_mov_b32 v90, 0
    v_mov_b32 v91, 0
    v_mov_b32 v92, 0
    v_mov_b32 v93, 0
    v_mov_b32 v94, 0
    v_mov_b32 v95, 0
    v_mov_b32 v96, 0
    v_mov_b32 v97, 0
    v_mov_b32 v98, 0
    v_mov_b32 v99, 0
    v_mov_b32 v100, 0
    v_mov_b32 v101, 0
    v_mov_b32 v102, 0
    v_mov_b32 v103, 0
    v_mov_b32 v104, 0
    v_mov_b32 v105, 0
    v_mov_b32 v106, 0
    v_mov_b32 v107, 0
    v_mov_b32 v108, 0
    v_mov_b32 v109, 0
    v_mov_b32 v110, 0
    v_mov_b32 v111, 0
    s_waitcnt lgkmcnt(0)
    s_mov_b32 s66, 0
.vloop_34:
    ds_read_b128 v[20:23], v55 offset:0
    s_waitcnt vmcnt(30)
    v_add_u32 v160, s21, v12
    v_add_u32 v161, s21, v13
    v_add_u32 v162, s21, v14
    v_add_u32 v163, s21, v15
    ds_read_b64_tr_b16 v[112:113], v160 offset:0
    ds_read_b64_tr_b16 v[116:117], v161 offset:0
    ds_read_b64_tr_b16 v[120:121], v162 offset:0
    ds_read_b64_tr_b16 v[124:125], v163 offset:0
    ds_read_b64_tr_b16 v[128:129], v160 offset:128
    ds_read_b64_tr_b16 v[132:133], v161 offset:128
    ds_read_b64_tr_b16 v[136:137], v162 offset:128
    ds_read_b64_tr_b16 v[140:141], v163 offset:128
    ds_read_b64_tr_b16 v[144:145], v160 offset:256
    ds_read_b64_tr_b16 v[148:149], v161 offset:256
    ds_read_b64_tr_b16 v[152:153], v162 offset:256
    ds_read_b64_tr_b16 v[156:157], v163 offset:256
    s_add_u32 s21, s21, 6144
    s_cmp_eq_u32 s21, 36864
    s_cselect_b32 s21, 0, s21
    s_waitcnt lgkmcnt(0)
    s_cmp_lt_u32 s61, 1024
    s_cselect_b32 s4, s16, s18
    s_cselect_b32 s5, s17, s19
    s_add_u32 s29, s64, 12288
    s_add_u32 m0, s23, s22
    s_add_u32 s30, s29, 3072
    buffer_load_dwordx4 v2, s[4:7], s29 offen offset:0 nt lds
    buffer_load_dwordx4 v3, s[4:7], s29 offen offset:1024 nt lds
    buffer_load_dwordx4 v4, s[4:7], s29 offen offset:2048 nt lds
    s_add_u32 m0, m0, 3072
    s_nop 0
    buffer_load_dwordx4 v2, s[4:7], s30 offen offset:0 nt lds
    buffer_load_dwordx4 v3, s[4:7], s30 offen offset:1024 nt lds
    buffer_load_dwordx4 v4, s[4:7], s30 offen offset:2048 nt lds
    s_add_u32 s22, s22, 6144
    s_cmp_eq_u32 s22, 36864
    s_cselect_b32 s22, 0, s22
    s_waitcnt vmcnt(30)
    v_add_u32 v160, s21, v12
    v_add_u32 v161, s21, v13
    v_add_u32 v162, s21, v14
    v_add_u32 v163, s21, v15
    ds_read_b64_tr_b16 v[114:115], v160 offset:0
    ds_read_b64_tr_b16 v[118:119], v161 offset:0
    ds_read_b64_tr_b16 v[122:123], v162 offset:0
    ds_read_b64_tr_b16 v[126:127], v163 offset:0
    ds_read_b64_tr_b16 v[130:131], v160 offset:128
    ds_read_b64_tr_b16 v[134:135], v161 offset:128
    ds_read_b64_tr_b16 v[138:139], v162 offset:128
    ds_read_b64_tr_b16 v[142:143], v163 offset:128
    ds_read_b64_tr_b16 v[146:147], v160 offset:256
    ds_read_b64_tr_b16 v[150:151], v161 offset:256
    ds_read_b64_tr_b16 v[154:155], v162 offset:256
    ds_read_b64_tr_b16 v[158:159], v163 offset:256
    s_add_u32 s21, s21, 6144
    s_cmp_eq_u32 s21, 36864
    s_cselect_b32 s21, 0, s21
    s_waitcnt lgkmcnt(0)
    s_cmp_lt_u32 s61, 1024
    s_cselect_b32 s4, s16, s18
    s_cselect_b32 s5, s17, s19
    s_add_u32 s29, s64, 18432
    s_add_u32 m0, s23, s22
    s_add_u32 s30, s29, 3072
    buffer_load_dwordx4 v2, s[4:7], s29 offen offset:0 nt lds
    buffer_load_dwordx4 v3, s[4:7], s29 offen offset:1024 nt lds
    buffer_load_dwordx4 v4, s[4:7], s29 offen offset:2048 nt lds
    s_add_u32 m0, m0, 3072
    s_nop 0
    buffer_load_dwordx4 v2, s[4:7], s30 offen offset:0 nt lds
    buffer_load_dwordx4 v3, s[4:7], s30 offen offset:1024 nt lds
    buffer_load_dwordx4 v4, s[4:7], s30 offen offset:2048 nt lds
    s_add_u32 s22, s22, 6144
    s_cmp_eq_u32 s22, 36864
    s_cselect_b32 s22, 0, s22
    v_mfma_f32_16x16x32_bf16 v[64:67], v[20:23], v[112:115], v[64:67]
    v_mfma_f32_16x16x32_bf16 v[68:71], v[20:23], v[116:119], v[68:71]
    v_mfma_f32_16x16x32_bf16 v[72:75], v[20:23], v[120:123], v[72:75]
    v_mfma_f32_16x16x32_bf16 v[76:79], v[20:23], v[124:127], v[76:79]
    v_mfma_f32_16x16x32_bf16 v[80:83], v[20:23], v[128:131], v[80:83]
    v_mfma_f32_16x16x32_bf16 v[84:87], v[20:23], v[132:135], v[84:87]
    v_mfma_f32_16x16x32_bf16 v[88:91], v[20:23], v[136:139], v[88:91]
    v_mfma_f32_16x16x32_bf16 v[92:95], v[20:23], v[140:143], v[92:95]
    v_mfma_f32_16x16x32_bf16 v[96:99], v[20:23], v[144:147], v[96:99]
    v_mfma_f32_16x16x32_bf16 v[100:103], v[20:23], v[148:151], v[100:103]
    v_mfma_f32_16x16x32_bf16 v[104:107], v[20:23], v[152:155], v[104:107]
    v_mfma_f32_16x16x32_bf16 v[108:111], v[20:23], v[156:159], v[108:111]
    ds_read_b128 v[20:23], v55 offset:64
    s_waitcnt vmcnt(30)
    v_add_u32 v160, s21, v12
    v_add_u32 v161, s21, v13
    v_add_u32 v162, s21, v14
    v_add_u32 v163, s21, v15
    ds_read_b64_tr_b16 v[112:113], v160 offset:0
    ds_read_b64_tr_b16 v[116:117], v161 offset:0
    ds_read_b64_tr_b16 v[120:121], v162 offset:0
    ds_read_b64_tr_b16 v[124:125], v163 offset:0
    ds_read_b64_tr_b16 v[128:129], v160 offset:128
    ds_read_b64_tr_b16 v[132:133], v161 offset:128
    ds_read_b64_tr_b16 v[136:137], v162 offset:128
    ds_read_b64_tr_b16 v[140:141], v163 offset:128
    ds_read_b64_tr_b16 v[144:145], v160 offset:256
    ds_read_b64_tr_b16 v[148:149], v161 offset:256
    ds_read_b64_tr_b16 v[152:153], v162 offset:256
    ds_read_b64_tr_b16 v[156:157], v163 offset:256
    s_add_u32 s21, s21, 6144
    s_cmp_eq_u32 s21, 36864
    s_cselect_b32 s21, 0, s21
    s_waitcnt lgkmcnt(0)
.Lg_top5:
    s_cmp_ge_u32 s44, 2
    s_cbranch_scc1 .Lg_v5
    s_cmp_lt_u32 s45, 7
    s_cbranch_scc1 .Lg_static5
    s_cmp_lg_u32 s49, 0x7fffffff
    s_cbranch_scc1 .Lg_bk5
    v_mov_b32 v62, 162844
.Lg_bs5:
    ds_read_b32 v59, v62
    s_waitcnt lgkmcnt(0)
    v_readfirstlane_b32 s49, v59
    s_nop 0
    s_cmp_eq_u32 s49, 0x7fffffff
    s_cbranch_scc0 .Lg_bk5
    s_sleep 1
    s_branch .Lg_bs5
.Lg_bk5:
    s_cmp_eq_u32 s44, 0
    s_cselect_b32 s28, 2, 2
    s_mul_i32 s28, s28, s49
    s_add_u32 s28, s28, 4
    s_and_b32 s29, s2, 1
    s_cmp_eq_u32 s29, 0
    s_cselect_b32 s29, 0, s28
    s_cselect_b32 s30, s28, 8
    s_sub_u32 s28, s45, 7
    s_lshl_b32 s28, s28, 2
    s_add_u32 s28, s28, s20
    s_add_u32 s28, s28, s29
    s_cmp_ge_u32 s28, s30
    s_cbranch_scc1 .Lg_next5
    s_add_u32 s45, s45, 1
    s_lshr_b32 s29, s26, 1
    s_lshl_b32 s29, s29, 3
    s_add_u32 s28, s28, s29
    s_add_u32 s28, s28, 448
    s_branch .Lg_rec5
.Lg_next5:
    s_add_u32 s44, s44, 1
    s_mov_b32 s45, 0
    s_branch .Lg_top5
.Lg_static5:
    s_mul_i32 s28, s27, 7
    s_add_u32 s28, s28, s45
    s_add_u32 s45, s45, 1
.Lg_rec5:
    s_cmp_eq_u32 s44, 0
    s_cselect_b32 s29, s47, s48
    s_lshl_b32 s30, s44, 4
    s_add_u32 s30, s30, s29
    s_add_u32 s29, s29, 1
    s_cmp_eq_u32 s44, 0
    s_cselect_b32 s47, s29, s47
    s_cselect_b32 s48, s48, s29
    s_mov_b32 m0, s30
    s_nop 0
    v_writelane_b32 v63, s28, m0
    s_branch .Lg_emit5
.Lg_v5:
    s_cmp_ge_u32 s44, 4
    s_cbranch_scc1 .Lg_end5
    s_cmp_eq_u32 s44, 2
    s_cselect_b32 s29, s47, s48
    s_cmp_lt_u32 s45, s29
    s_cbranch_scc1 .Lg_rep5
    s_add_u32 s44, s44, 1
    s_mov_b32 s45, 0
    s_branch .Lg_v5
.Lg_rep5:
    s_sub_u32 s30, s44, 2
    s_lshl_b32 s30, s30, 4
    s_add_u32 s30, s30, s45
    s_add_u32 s45, s45, 1
    s_nop 1
    v_readlane_b32 s28, v63, s30
.Lg_emit5:
    s_lshl_b32 s29, s44, 9
    s_or_b32 s62, s29, s28
    s_and_b32 s29, s44, 1
    s_mul_i32 s29, s29, 12582912
    s_mul_i32 s28, s28, 24576
    s_add_u32 s28, s28, s29
    s_add_u32 s65, s28, s24
    s_branch .Lg_out5
.Lg_end5:
    s_mov_b32 s62, -1
    s_mov_b32 s65, 0x80000000
.Lg_out5:
    s_cmp_lt_u32 s62, 1024
    s_cselect_b32 s4, s16, s18
    s_cselect_b32 s5, s17, s19
    s_add_u32 s29, s65, 0
    s_add_u32 m0, s23, s22
    s_add_u32 s30, s29, 3072
    buffer_load_dwordx4 v2, s[4:7], s29 offen offset:0 nt lds
    buffer_load_dwordx4 v3, s[4:7], s29 offen offset:1024 nt lds
    buffer_load_dwordx4 v4, s[4:7], s29 offen offset:2048 nt lds
    s_add_u32 m0, m0, 3072
    s_nop 0
    buffer_load_dwordx4 v2, s[4:7], s30 offen offset:0 nt lds
    buffer_load_dwordx4 v3, s[4:7], s30 offen offset:1024 nt lds
    buffer_load_dwordx4 v4, s[4:7], s30 offen offset:2048 nt lds
    s_add_u32 s22, s22, 6144
    s_cmp_eq_u32 s22, 36864
    s_cselect_b32 s22, 0, s22
    s_waitcnt vmcnt(30)
    v_add_u32 v160, s21, v12
    v_add_u32 v161, s21, v13
    v_add_u32 v162, s21, v14
    v_add_u32 v163, s21, v15
    ds_read_b64_tr_b16 v[114:115], v160 offset:0
    ds_read_b64_tr_b16 v[118:119], v161 offset:0
    ds_read_b64_tr_b16 v[122:123], v162 offset:0
    ds_read_b64_tr_b16 v[126:127], v163 offset:0
    ds_read_b64_tr_b16 v[130:131], v160 offset:128
    ds_read_b64_tr_b16 v[134:135], v161 offset:128
    ds_read_b64_tr_b16 v[138:139], v162 offset:128
    ds_read_b64_tr_b16 v[142:143], v163 offset:128
    ds_read_b64_tr_b16 v[146:147], v160 offset:256
    ds_read_b64_tr_b16 v[150:151], v161 offset:256
    ds_read_b64_tr_b16 v[154:155], v162 offset:256
    ds_read_b64_tr_b16 v[158:159], v163 offset:256
    s_add_u32 s21, s21, 6144
    s_cmp_eq_u32 s21, 36864
    s_cselect_b32 s21, 0, s21
    s_waitcnt lgkmcnt(0)
    s_cmp_lt_u32 s62, 1024
    s_cselect_b32 s4, s16, s18
    s_cselect_b32 s5, s17, s19
    s_add_u32 s29, s65, 6144
    s_add_u32 m0, s23, s22
    s_add_u32 s30, s29, 3072
    buffer_load_dwordx4 v2, s[4:7], s29 offen offset:0 nt lds
    buffer_load_dwordx4 v3, s[4:7], s29 offen offset:1024 nt lds
    buffer_load_dwordx4 v4, s[4:7], s29 offen offset:2048 nt lds
    s_add_u32 m0, m0, 3072
    s_nop 0
    buffer_load_dwordx4 v2, s[4:7], s30 offen offset:0 nt lds
    buffer_load_dwordx4 v3, s[4:7], s30 offen offset:1024 nt lds
    buffer_load_dwordx4 v4, s[4:7], s30 offen offset:2048 nt lds
    s_add_u32 s22, s22, 6144
    s_cmp_eq_u32 s22, 36864
    s_cselect_b32 s22, 0, s22
    v_mfma_f32_16x16x32_bf16 v[64:67], v[20:23], v[112:115], v[64:67]
    v_mfma_f32_16x16x32_bf16 v[68:71], v[20:23], v[116:119], v[68:71]
    v_mfma_f32_16x16x32_bf16 v[72:75], v[20:23], v[120:123], v[72:75]
    v_mfma_f32_16x16x32_bf16 v[76:79], v[20:23], v[124:127], v[76:79]
    v_mfma_f32_16x16x32_bf16 v[80:83], v[20:23], v[128:131], v[80:83]
    v_mfma_f32_16x16x32_bf16 v[84:87], v[20:23], v[132:135], v[84:87]
    v_mfma_f32_16x16x32_bf16 v[88:91], v[20:23], v[136:139], v[88:91]
    v_mfma_f32_16x16x32_bf16 v[92:95], v[20:23], v[140:143], v[92:95]
    v_mfma_f32_16x16x32_bf16 v[96:99], v[20:23], v[144:147], v[96:99]
    v_mfma_f32_16x16x32_bf16 v[100:103], v[20:23], v[148:151], v[100:103]
    v_mfma_f32_16x16x32_bf16 v[104:107], v[20:23], v[152:155], v[104:107]
    v_mfma_f32_16x16x32_bf16 v[108:111], v[20:23], v[156:159], v[108:111]
    s_cmp_lg_u32 s66, 4
    s_cbranch_scc1 .skip_35
    buffer_load_dword v57, v52, s[12:15], 0 offen offset:128 sc1
    s_lshl_b32 s35, s25, 10
    s_add_u32 s35, s35, 33280
    v_lshlrev_b32 v56, 3, v1
    buffer_load_dwordx2 v[50:51], v56, s[8:11], s35 offen sc1
.skip_35:
    v_add_u32 v55, 128, v55
    s_mov_b32 s60, s61
    s_mov_b32 s63, s64
    s_mov_b32 s61, s62
    s_mov_b32 s64, s65
    s_add_u32 s66, s66, 1
    s_lshr_b32 s28, s60, 9
    s_cmp_eq_u32 s28, 2
    s_cbranch_scc1 .vloop_34
    s_nop 7
    s_nop 1
    v_lshlrev_b32 v56, 2, v1
    v_add_u32 v56, s34, v56
    s_mov_b64 exec, 0xffff
    ds_write_b32 v56, v64 offset:0
    ds_write_b32 v56, v68 offset:64
    ds_write_b32 v56, v72 offset:128
    ds_write_b32 v56, v76 offset:192
    ds_write_b32 v56, v80 offset:256
    ds_write_b32 v56, v84 offset:320
    ds_write_b32 v56, v88 offset:384
    ds_write_b32 v56, v92 offset:448
    ds_write_b32 v56, v96 offset:512
    ds_write_b32 v56, v100 offset:576
    ds_write_b32 v56, v104 offset:640
    ds_write_b32 v56, v108 offset:704
    s_mov_b64 exec, -1
    s_getpc_b64 s[28:29]
    .Lpc_ref:
    v_lshlrev_b32 v58, 4, v1
    s_lshl_b32 s30, s20, 12
    v_add_u32 v58, s30, v58
    v_add_u32 v58, .Ltail-.Lpc_ref, v58
    v_min_u32 v59, .Lend-.Lpc_ref-12, v58
    global_load_dwordx4 v[252:255], v59, s[28:29]
    v_add_u32 v58, 1024, v58
    v_min_u32 v59, .Lend-.Lpc_ref-12, v58
    global_load_dwordx4 v[252:255], v59, s[28:29]
    v_add_u32 v58, 1024, v58
    v_min_u32 v59, .Lend-.Lpc_ref-12, v58
    global_load_dwordx4 v[252:255], v59, s[28:29]
    v_add_u32 v58, 1024, v58
    v_min_u32 v59, .Lend-.Lpc_ref-12, v58
    global_load_dwordx4 v[252:255], v59, s[28:29]
    v_add_u32 v58, 1024, v58
    v_cmp_gt_u32 vcc, 256, v57
    s_cbranch_vccnz .mlslow_37
    v_max_u32 v53, v50, v51
    v_cmp_eq_u32 vcc, -1, v53
    s_cbranch_vccz .mlok_36
.mlslow_37:
    s_mov_b32 s39, 0
.pc_38:
    buffer_load_dword v53, v52, s[12:15], 0 offen offset:128 sc1
    s_waitcnt vmcnt(0)
    v_readfirstlane_b32 s38, v53
    s_nop 0
    s_cmp_ge_u32 s38, 256
    s_cbranch_scc1 .pcd_39
    s_add_u32 s39, s39, 1
    s_cmp_gt_u32 s39, 400000
    s_cbranch_scc1 .pcd_39
    s_sleep 1
    s_branch .pc_38
.pcd_39:
    s_mov_b32 s39, 0
.poll_40:
    buffer_load_dword v57, v52, s[12:15], 0 offen offset:128 sc1
    s_lshl_b32 s35, s25, 10
    s_add_u32 s35, s35, 33280
    v_lshlrev_b32 v56, 3, v1
    buffer_load_dwordx2 v[50:51], v56, s[8:11], s35 offen sc1
    s_waitcnt vmcnt(0)
    v_mov_b32 v53, v50
    v_max_u32 v53, v53, v51
    v_cmp_eq_u32 vcc, -1, v53
    s_cbranch_vccz .polld_41
    s_add_u32 s39, s39, 1
    s_cmp_gt_u32 s39, 400000
    s_cbranch_scc1 .polld_41
    s_sleep 1
    s_branch .poll_40
.polld_41:
.mlok_36:
    v_mov_b32 v44, v50
    s_nop 1
    v_max_f32_dpp v44, v44, v44 quad_perm:[1,0,3,2] row_mask:0xf bank_mask:0xf
    s_nop 1
    v_max_f32_dpp v44, v44, v44 quad_perm:[2,3,0,1] row_mask:0xf bank_mask:0xf
    s_nop 1
    v_max_f32_dpp v44, v44, v44 row_half_mirror row_mask:0xf bank_mask:0xf
    s_nop 1
    v_max_f32_dpp v44, v44, v44 row_mirror row_mask:0xf bank_mask:0xf
    s_nop 1
    v_readlane_b32 s40, v44, 0
    v_readlane_b32 s41, v44, 16
    v_readlane_b32 s42, v44, 32
    v_readlane_b32 s43, v44, 48
    s_nop 1
    v_mov_b32 v44, s40
    v_max_f32 v44, s41, v44
    v_max_f32 v44, s42, v44
    v_max_f32 v44, s43, v44
    v_sub_f32 v45, v50, v44
    v_mul_f32 v45, 1069066811, v45
    v_exp_f32 v45, v45
    s_nop 0
    v_mul_f32 v45, v45, v51
    s_nop 1
    v_add_f32_dpp v45, v45, v45 quad_perm:[1,0,3,2] row_mask:0xf bank_mask:0xf
    s_nop 1
    v_add_f32_dpp v45, v45, v45 quad_perm:[2,3,0,1] row_mask:0xf bank_mask:0xf
    s_nop 1
    v_add_f32_dpp v45, v45, v45 row_half_mirror row_mask:0xf bank_mask:0xf
    s_nop 1
    v_add_f32_dpp v45, v45, v45 row_mirror row_mask:0xf bank_mask:0xf
    s_nop 1
    v_readlane_b32 s40, v45, 0
    v_readlane_b32 s41, v45, 16
    v_readlane_b32 s42, v45, 32
    v_readlane_b32 s43, v45, 48
    s_nop 1
    v_mov_b32 v45, s40
    v_add_f32 v45, s41, v45
    v_add_f32 v45, s42, v45
    v_add_f32 v45, s43, v45
    s_add_u32 s34, s32, 7168
    v_lshlrev_b32 v55, 1, v1
    v_add_u32 v55, s34, v55
    v_and_b32 v30, 31, v1
    v_bfe_u32 v31, v30, 2, 2
    v_lshlrev_b32 v31, 3, v31
    v_bfe_u32 v32, v30, 4, 1
    v_lshl_add_u32 v31, v32, 2, v31
    v_and_b32 v32, 3, v30
    v_add_u32 v31, v31, v32
    v_lshlrev_b32 v31, 1, v31
    v_lshrrev_b32 v32, 5, v1
    v_lshl_add_u32 v31, v32, 6, v31
    v_add_u32 v31, s34, v31
    s_mov_b32 s66, 0
.ploop_42:
    ds_read_u16 v47, v55
    v_add_u32 v55, 128, v55
    s_waitcnt lgkmcnt(0)
    v_lshlrev_b32 v47, 16, v47
    v_sub_f32 v47, v47, v44
    v_mul_f32 v47, 1069066811, v47
    v_exp_f32 v47, v47
    v_mov_b32 v49, v45
    v_rcp_f32 v56, v49
    s_nop 0
    v_mul_f32 v53, v47, v56
    v_fma_f32 v49, -v53, v49, v47
    v_fma_f32 v47, v49, v56, v53
    v_cvt_pk_bf16_f32 v47, v47, v47
    ds_write_b16 v31, v47
    v_add_u32 v31, 128, v31
    s_add_u32 s66, s66, 1
    s_cmp_lt_u32 s66, s48
    s_cbranch_scc1 .ploop_42
    v_lshlrev_b32 v55, 4, v6
    v_add_u32 v55, s34, v55
    v_mov_b32 v64, 0
    v_mov_b32 v65, 0
    v_mov_b32 v66, 0
    v_mov_b32 v67, 0
    v_mov_b32 v68, 0
    v_mov_b32 v69, 0
    v_mov_b32 v70, 0
    v_mov_b32 v71, 0
    v_mov_b32 v72, 0
    v_mov_b32 v73, 0
    v_mov_b32 v74, 0
    v_mov_b32 v75, 0
    v_mov_b32 v76, 0
    v_mov_b32 v77, 0
    v_mov_b32 v78, 0
    v_mov_b32 v79, 0
    v_mov_b32 v80, 0
    v_mov_b32 v81, 0
    v_mov_b32 v82, 0
    v_mov_b32 v83, 0
    v_mov_b32 v84, 0
    v_mov_b32 v85, 0
    v_mov_b32 v86, 0
    v_mov_b32 v87, 0
    v_mov_b32 v88, 0
    v_mov_b32 v89, 0
    v_mov_b32 v90, 0
    v_mov_b32 v91, 0
    v_mov_b32 v92, 0
    v_mov_b32 v93, 0
    v_mov_b32 v94, 0
    v_mov_b32 v95, 0
    v_mov_b32 v96, 0
    v_mov_b32 v97, 0
    v_mov_b32 v98, 0
    v_mov_b32 v99, 0
    v_mov_b32 v100, 0
    v_mov_b32 v101, 0
    v_mov_b32 v102, 0
    v_mov_b32 v103, 0
    v_mov_b32 v104, 0
    v_mov_b32 v105, 0
    v_mov_b32 v106, 0
    v_mov_b32 v107, 0
    v_mov_b32 v108, 0
    v_mov_b32 v109, 0
    v_mov_b32 v110, 0
    v_mov_b32 v111, 0
    s_waitcnt lgkmcnt(0)
    s_mov_b32 s66, 0
.vloop_43:
    ds_read_b128 v[20:23], v55 offset:0
    s_waitcnt vmcnt(30)
    v_add_u32 v160, s21, v12
    v_add_u32 v161, s21, v13
    v_add_u32 v162, s21, v14
    v_add_u32 v163, s21, v15
    ds_read_b64_tr_b16 v[112:113], v160 offset:0
    ds_read_b64_tr_b16 v[116:117], v161 offset:0
    ds_read_b64_tr_b16 v[120:121], v162 offset:0
    ds_read_b64_tr_b16 v[124:125], v163 offset:0
    ds_read_b64_tr_b16 v[128:129], v160 offset:128
    ds_read_b64_tr_b16 v[132:133], v161 offset:128
    ds_read_b64_tr_b16 v[136:137], v162 offset:128
    ds_read_b64_tr_b16 v[140:141], v163 offset:128
    ds_read_b64_tr_b16 v[144:145], v160 offset:256
    ds_read_b64_tr_b16 v[148:149], v161 offset:256
    ds_read_b64_tr_b16 v[152:153], v162 offset:256
    ds_read_b64_tr_b16 v[156:157], v163 offset:256
    s_add_u32 s21, s21, 6144
    s_cmp_eq_u32 s21, 36864
    s_cselect_b32 s21, 0, s21
    s_waitcnt lgkmcnt(0)
    s_cmp_lt_u32 s61, 1024
    s_cselect_b32 s4, s16, s18
    s_cselect_b32 s5, s17, s19
    s_add_u32 s29, s64, 12288
    s_add_u32 m0, s23, s22
    s_add_u32 s30, s29, 3072
    buffer_load_dwordx4 v2, s[4:7], s29 offen offset:0 nt lds
    buffer_load_dwordx4 v3, s[4:7], s29 offen offset:1024 nt lds
    buffer_load_dwordx4 v4, s[4:7], s29 offen offset:2048 nt lds
    s_add_u32 m0, m0, 3072
    s_nop 0
    buffer_load_dwordx4 v2, s[4:7], s30 offen offset:0 nt lds
    buffer_load_dwordx4 v3, s[4:7], s30 offen offset:1024 nt lds
    buffer_load_dwordx4 v4, s[4:7], s30 offen offset:2048 nt lds
    s_add_u32 s22, s22, 6144
    s_cmp_eq_u32 s22, 36864
    s_cselect_b32 s22, 0, s22
    s_waitcnt vmcnt(30)
    v_add_u32 v160, s21, v12
    v_add_u32 v161, s21, v13
    v_add_u32 v162, s21, v14
    v_add_u32 v163, s21, v15
    ds_read_b64_tr_b16 v[114:115], v160 offset:0
    ds_read_b64_tr_b16 v[118:119], v161 offset:0
    ds_read_b64_tr_b16 v[122:123], v162 offset:0
    ds_read_b64_tr_b16 v[126:127], v163 offset:0
    ds_read_b64_tr_b16 v[130:131], v160 offset:128
    ds_read_b64_tr_b16 v[134:135], v161 offset:128
    ds_read_b64_tr_b16 v[138:139], v162 offset:128
    ds_read_b64_tr_b16 v[142:143], v163 offset:128
    ds_read_b64_tr_b16 v[146:147], v160 offset:256
    ds_read_b64_tr_b16 v[150:151], v161 offset:256
    ds_read_b64_tr_b16 v[154:155], v162 offset:256
    ds_read_b64_tr_b16 v[158:159], v163 offset:256
    s_add_u32 s21, s21, 6144
    s_cmp_eq_u32 s21, 36864
    s_cselect_b32 s21, 0, s21
    s_waitcnt lgkmcnt(0)
    s_cmp_lt_u32 s61, 1024
    s_cselect_b32 s4, s16, s18
    s_cselect_b32 s5, s17, s19
    s_add_u32 s29, s64, 18432
    s_add_u32 m0, s23, s22
    s_add_u32 s30, s29, 3072
    buffer_load_dwordx4 v2, s[4:7], s29 offen offset:0 nt lds
    buffer_load_dwordx4 v3, s[4:7], s29 offen offset:1024 nt lds
    buffer_load_dwordx4 v4, s[4:7], s29 offen offset:2048 nt lds
    s_add_u32 m0, m0, 3072
    s_nop 0
    buffer_load_dwordx4 v2, s[4:7], s30 offen offset:0 nt lds
    buffer_load_dwordx4 v3, s[4:7], s30 offen offset:1024 nt lds
    buffer_load_dwordx4 v4, s[4:7], s30 offen offset:2048 nt lds
    s_add_u32 s22, s22, 6144
    s_cmp_eq_u32 s22, 36864
    s_cselect_b32 s22, 0, s22
    v_mfma_f32_16x16x32_bf16 v[64:67], v[20:23], v[112:115], v[64:67]
    v_mfma_f32_16x16x32_bf16 v[68:71], v[20:23], v[116:119], v[68:71]
    v_mfma_f32_16x16x32_bf16 v[72:75], v[20:23], v[120:123], v[72:75]
    v_mfma_f32_16x16x32_bf16 v[76:79], v[20:23], v[124:127], v[76:79]
    v_mfma_f32_16x16x32_bf16 v[80:83], v[20:23], v[128:131], v[80:83]
    v_mfma_f32_16x16x32_bf16 v[84:87], v[20:23], v[132:135], v[84:87]
    v_mfma_f32_16x16x32_bf16 v[88:91], v[20:23], v[136:139], v[88:91]
    v_mfma_f32_16x16x32_bf16 v[92:95], v[20:23], v[140:143], v[92:95]
    v_mfma_f32_16x16x32_bf16 v[96:99], v[20:23], v[144:147], v[96:99]
    v_mfma_f32_16x16x32_bf16 v[100:103], v[20:23], v[148:151], v[100:103]
    v_mfma_f32_16x16x32_bf16 v[104:107], v[20:23], v[152:155], v[104:107]
    v_mfma_f32_16x16x32_bf16 v[108:111], v[20:23], v[156:159], v[108:111]
    ds_read_b128 v[20:23], v55 offset:64
    s_waitcnt vmcnt(30)
    v_add_u32 v160, s21, v12
    v_add_u32 v161, s21, v13
    v_add_u32 v162, s21, v14
    v_add_u32 v163, s21, v15
    ds_read_b64_tr_b16 v[112:113], v160 offset:0
    ds_read_b64_tr_b16 v[116:117], v161 offset:0
    ds_read_b64_tr_b16 v[120:121], v162 offset:0
    ds_read_b64_tr_b16 v[124:125], v163 offset:0
    ds_read_b64_tr_b16 v[128:129], v160 offset:128
    ds_read_b64_tr_b16 v[132:133], v161 offset:128
    ds_read_b64_tr_b16 v[136:137], v162 offset:128
    ds_read_b64_tr_b16 v[140:141], v163 offset:128
    ds_read_b64_tr_b16 v[144:145], v160 offset:256
    ds_read_b64_tr_b16 v[148:149], v161 offset:256
    ds_read_b64_tr_b16 v[152:153], v162 offset:256
    ds_read_b64_tr_b16 v[156:157], v163 offset:256
    s_add_u32 s21, s21, 6144
    s_cmp_eq_u32 s21, 36864
    s_cselect_b32 s21, 0, s21
    s_waitcnt lgkmcnt(0)
.Lg_top6:
    s_cmp_ge_u32 s44, 2
    s_cbranch_scc1 .Lg_v6
    s_cmp_lt_u32 s45, 7
    s_cbranch_scc1 .Lg_static6
    s_cmp_lg_u32 s49, 0x7fffffff
    s_cbranch_scc1 .Lg_bk6
    v_mov_b32 v62, 162844
.Lg_bs6:
    ds_read_b32 v59, v62
    s_waitcnt lgkmcnt(0)
    v_readfirstlane_b32 s49, v59
    s_nop 0
    s_cmp_eq_u32 s49, 0x7fffffff
    s_cbranch_scc0 .Lg_bk6
    s_sleep 1
    s_branch .Lg_bs6
.Lg_bk6:
    s_cmp_eq_u32 s44, 0
    s_cselect_b32 s28, 2, 2
    s_mul_i32 s28, s28, s49
    s_add_u32 s28, s28, 4
    s_and_b32 s29, s2, 1
    s_cmp_eq_u32 s29, 0
    s_cselect_b32 s29, 0, s28
    s_cselect_b32 s30, s28, 8
    s_sub_u32 s28, s45, 7
    s_lshl_b32 s28, s28, 2
    s_add_u32 s28, s28, s20
    s_add_u32 s28, s28, s29
    s_cmp_ge_u32 s28, s30
    s_cbranch_scc1 .Lg_next6
    s_add_u32 s45, s45, 1
    s_lshr_b32 s29, s26, 1
    s_lshl_b32 s29, s29, 3
    s_add_u32 s28, s28, s29
    s_add_u32 s28, s28, 448
    s_branch .Lg_rec6
.Lg_next6:
    s_add_u32 s44, s44, 1
    s_mov_b32 s45, 0
    s_branch .Lg_top6
.Lg_static6:
    s_mul_i32 s28, s27, 7
    s_add_u32 s28, s28, s45
    s_add_u32 s45, s45, 1
.Lg_rec6:
    s_cmp_eq_u32 s44, 0
    s_cselect_b32 s29, s47, s48
    s_lshl_b32 s30, s44, 4
    s_add_u32 s30, s30, s29
    s_add_u32 s29, s29, 1
    s_cmp_eq_u32 s44, 0
    s_cselect_b32 s47, s29, s47
    s_cselect_b32 s48, s48, s29
    s_mov_b32 m0, s30
    s_nop 0
    v_writelane_b32 v63, s28, m0
    s_branch .Lg_emit6
.Lg_v6:
    s_cmp_ge_u32 s44, 4
    s_cbranch_scc1 .Lg_end6
    s_cmp_eq_u32 s44, 2
    s_cselect_b32 s29, s47, s48
    s_cmp_lt_u32 s45, s29
    s_cbranch_scc1 .Lg_rep6
    s_add_u32 s44, s44, 1
    s_mov_b32 s45, 0
    s_branch .Lg_v6
.Lg_rep6:
    s_sub_u32 s30, s44, 2
    s_lshl_b32 s30, s30, 4
    s_add_u32 s30, s30, s45
    s_add_u32 s45, s45, 1
    s_nop 1
    v_readlane_b32 s28, v63, s30
.Lg_emit6:
    s_lshl_b32 s29, s44, 9
    s_or_b32 s62, s29, s28
    s_and_b32 s29, s44, 1
    s_mul_i32 s29, s29, 12582912
    s_mul_i32 s28, s28, 24576
    s_add_u32 s28, s28, s29
    s_add_u32 s65, s28, s24
    s_branch .Lg_out6
.Lg_end6:
    s_mov_b32 s62, -1
    s_mov_b32 s65, 0x80000000
.Lg_out6:
    s_cmp_lt_u32 s62, 1024
    s_cselect_b32 s4, s16, s18
    s_cselect_b32 s5, s17, s19
    s_add_u32 s29, s65, 0
    s_add_u32 m0, s23, s22
    s_add_u32 s30, s29, 3072
    buffer_load_dwordx4 v2, s[4:7], s29 offen offset:0 nt lds
    buffer_load_dwordx4 v3, s[4:7], s29 offen offset:1024 nt lds
    buffer_load_dwordx4 v4, s[4:7], s29 offen offset:2048 nt lds
    s_add_u32 m0, m0, 3072
    s_nop 0
    buffer_load_dwordx4 v2, s[4:7], s30 offen offset:0 nt lds
    buffer_load_dwordx4 v3, s[4:7], s30 offen offset:1024 nt lds
    buffer_load_dwordx4 v4, s[4:7], s30 offen offset:2048 nt lds
    s_add_u32 s22, s22, 6144
    s_cmp_eq_u32 s22, 36864
    s_cselect_b32 s22, 0, s22
    s_waitcnt vmcnt(30)
    v_add_u32 v160, s21, v12
    v_add_u32 v161, s21, v13
    v_add_u32 v162, s21, v14
    v_add_u32 v163, s21, v15
    ds_read_b64_tr_b16 v[114:115], v160 offset:0
    ds_read_b64_tr_b16 v[118:119], v161 offset:0
    ds_read_b64_tr_b16 v[122:123], v162 offset:0
    ds_read_b64_tr_b16 v[126:127], v163 offset:0
    ds_read_b64_tr_b16 v[130:131], v160 offset:128
    ds_read_b64_tr_b16 v[134:135], v161 offset:128
    ds_read_b64_tr_b16 v[138:139], v162 offset:128
    ds_read_b64_tr_b16 v[142:143], v163 offset:128
    ds_read_b64_tr_b16 v[146:147], v160 offset:256
    ds_read_b64_tr_b16 v[150:151], v161 offset:256
    ds_read_b64_tr_b16 v[154:155], v162 offset:256
    ds_read_b64_tr_b16 v[158:159], v163 offset:256
    s_add_u32 s21, s21, 6144
    s_cmp_eq_u32 s21, 36864
    s_cselect_b32 s21, 0, s21
    s_waitcnt lgkmcnt(0)
    s_cmp_lt_u32 s62, 1024
    s_cselect_b32 s4, s16, s18
    s_cselect_b32 s5, s17, s19
    s_add_u32 s29, s65, 6144
    s_add_u32 m0, s23, s22
    s_add_u32 s30, s29, 3072
    buffer_load_dwordx4 v2, s[4:7], s29 offen offset:0 nt lds
    buffer_load_dwordx4 v3, s[4:7], s29 offen offset:1024 nt lds
    buffer_load_dwordx4 v4, s[4:7], s29 offen offset:2048 nt lds
    s_add_u32 m0, m0, 3072
    s_nop 0
    buffer_load_dwordx4 v2, s[4:7], s30 offen offset:0 nt lds
    buffer_load_dwordx4 v3, s[4:7], s30 offen offset:1024 nt lds
    buffer_load_dwordx4 v4, s[4:7], s30 offen offset:2048 nt lds
    s_add_u32 s22, s22, 6144
    s_cmp_eq_u32 s22, 36864
    s_cselect_b32 s22, 0, s22
    v_mfma_f32_16x16x32_bf16 v[64:67], v[20:23], v[112:115], v[64:67]
    v_mfma_f32_16x16x32_bf16 v[68:71], v[20:23], v[116:119], v[68:71]
    v_mfma_f32_16x16x32_bf16 v[72:75], v[20:23], v[120:123], v[72:75]
    v_mfma_f32_16x16x32_bf16 v[76:79], v[20:23], v[124:127], v[76:79]
    v_mfma_f32_16x16x32_bf16 v[80:83], v[20:23], v[128:131], v[80:83]
    v_mfma_f32_16x16x32_bf16 v[84:87], v[20:23], v[132:135], v[84:87]
    v_mfma_f32_16x16x32_bf16 v[88:91], v[20:23], v[136:139], v[88:91]
    v_mfma_f32_16x16x32_bf16 v[92:95], v[20:23], v[140:143], v[92:95]
    v_mfma_f32_16x16x32_bf16 v[96:99], v[20:23], v[144:147], v[96:99]
    v_mfma_f32_16x16x32_bf16 v[100:103], v[20:23], v[148:151], v[100:103]
    v_mfma_f32_16x16x32_bf16 v[104:107], v[20:23], v[152:155], v[104:107]
    v_mfma_f32_16x16x32_bf16 v[108:111], v[20:23], v[156:159], v[108:111]
    v_add_u32 v55, 128, v55
    s_mov_b32 s60, s61
    s_mov_b32 s63, s64
    s_mov_b32 s61, s62
    s_mov_b32 s64, s65
    s_add_u32 s66, s66, 1
    s_lshr_b32 s28, s60, 9
    s_cmp_eq_u32 s28, 3
    s_cbranch_scc1 .vloop_43
    s_nop 7
    s_nop 1
    v_lshlrev_b32 v56, 2, v1
    v_add_u32 v56, s34, v56
    s_mov_b64 exec, 0xffff
    ds_write_b32 v56, v64 offset:0
    ds_write_b32 v56, v68 offset:64
    ds_write_b32 v56, v72 offset:128
    ds_write_b32 v56, v76 offset:192
    ds_write_b32 v56, v80 offset:256
    ds_write_b32 v56, v84 offset:320
    ds_write_b32 v56, v88 offset:384
    ds_write_b32 v56, v92 offset:448
    ds_write_b32 v56, v96 offset:512
    ds_write_b32 v56, v100 offset:576
    ds_write_b32 v56, v104 offset:640
    ds_write_b32 v56, v108 offset:704
    s_mov_b64 exec, -1
    s_waitcnt vmcnt(0) lgkmcnt(0)
    s_branch .Ltail
.Ltail:
    s_barrier
    v_lshlrev_b32 v3, 2, v1
    v_lshlrev_b32 v4, 2, v0
    v_mov_b32 v52, 0
    s_sub_u32 s27, s20, 4
    s_cmp_ge_u32 s20, 6
    s_cbranch_scc1 .Lt1_done
    v_cmp_le_u32 vcc, 192, v0
    v_mov_b32 v6, 6400
    s_nop 0
    v_cndmask_b32 v5, 0, v6, vcc
    v_add_u32 v5, v5, v4
    v_add_u32 v5, 147456, v5
    ds_read_b32 v20, v5 offset:0
    ds_read_b32 v21, v5 offset:1792
    ds_read_b32 v22, v5 offset:3584
    ds_read_b32 v23, v5 offset:5376
    s_waitcnt lgkmcnt(0)
    v_add_f32 v20, v20, v21
    v_add_f32 v22, v22, v23
    v_add_f32 v20, v20, v22
    v_mov_b32 v24, 0x7fc00000
    v_cmp_eq_u32 vcc, -1, v20
    s_nop 1
    v_cndmask_b32 v20, v20, v24, vcc
    s_mul_i32 s28, s2, 1536
    s_add_u32 s28, s28, 65536
    buffer_store_dword v20, v4, s[8:11], s28 offen sc0 sc1
.Lt1_done:
    s_cmp_ge_u32 s2, 160
    s_cbranch_scc1 .Lt3
    s_mul_hi_u32 s30, s2, 0x1999999a
    s_cmp_ge_u32 s20, 6
    s_cbranch_scc1 .Lt2_b
    s_mul_i32 s28, s30, 24576
    s_add_u32 s28, s28, 65536
    s_mov_b32 s39, 0
.poll_44:
    s_add_u32 s29, s28, 0
    buffer_load_dword v20, v4, s[8:11], s29 offen sc1
    s_add_u32 s29, s28, 1536
    buffer_load_dword v21, v4, s[8:11], s29 offen sc1
    s_add_u32 s29, s28, 3072
    buffer_load_dword v22, v4, s[8:11], s29 offen sc1
    s_add_u32 s29, s28, 4608
    buffer_load_dword v23, v4, s[8:11], s29 offen sc1
    s_add_u32 s29, s28, 6144
    buffer_load_dword v24, v4, s[8:11], s29 offen sc1
    s_add_u32 s29, s28, 7680
    buffer_load_dword v25, v4, s[8:11], s29 offen sc1
    s_add_u32 s29, s28, 9216
    buffer_load_dword v26, v4, s[8:11], s29 offen sc1
    s_add_u32 s29, s28, 10752
    buffer_load_dword v27, v4, s[8:11], s29 offen sc1
    s_add_u32 s29, s28, 12288
    buffer_load_dword v28, v4, s[8:11], s29 offen sc1
    s_add_u32 s29, s28, 13824
    buffer_load_dword v29, v4, s[8:11], s29 offen sc1
    s_add_u32 s29, s28, 15360
    buffer_load_dword v30, v4, s[8:11], s29 offen sc1
    s_add_u32 s29, s28, 16896
    buffer_load_dword v31, v4, s[8:11], s29 offen sc1
    s_add_u32 s29, s28, 18432
    buffer_load_dword v32, v4, s[8:11], s29 offen sc1
    s_add_u32 s29, s28, 19968
    buffer_load_dword v33, v4, s[8:11], s29 offen sc1
    s_add_u32 s29, s28, 21504
    buffer_load_dword v34, v4, s[8:11], s29 offen sc1
    s_add_u32 s29, s28, 23040
    buffer_load_dword v35, v4, s[8:11], s29 offen sc1
    s_waitcnt vmcnt(0)
    v_mov_b32 v53, v20
    v_max3_u32 v53, v53, v21, v22
    v_max3_u32 v53, v53, v23, v24
    v_max3_u32 v53, v53, v25, v26
    v_max3_u32 v53, v53, v27, v28
    v_max3_u32 v53, v53, v29, v30
    v_max3_u32 v53, v53, v31, v32
    v_max3_u32 v53, v53, v33, v34
    v_max_u32 v53, v53, v35
    v_cmp_eq_u32 vcc, -1, v53
    s_cbranch_vccz .polld_45
    s_add_u32 s39, s39, 1
    s_cmp_gt_u32 s39, 400000
    s_cbranch_scc1 .polld_45
    s_sleep 1
    s_branch .poll_44
.polld_45:
    v_add_f32 v20, v20, v21
    v_add_f32 v20, v20, v22
    v_add_f32 v20, v20, v23
    v_add_f32 v20, v20, v24
    v_add_f32 v20, v20, v25
    v_add_f32 v20, v20, v26
    v_add_f32 v20, v20, v27
    v_add_f32 v20, v20, v28
    v_add_f32 v20, v20, v29
    v_add_f32 v20, v20, v30
    v_add_f32 v20, v20, v31
    v_add_f32 v20, v20, v32
    v_add_f32 v20, v20, v33
    v_add_f32 v20, v20, v34
    v_add_f32 v20, v20, v35
    v_cvt_pk_bf16_f32 v21, v20, v20
    v_lshlrev_b32 v20, 16, v21
    ds_write_b32 v4, v20 offset:0
    s_waitcnt lgkmcnt(0)
.Lt2_b:
    s_barrier
    s_cmp_lt_u32 s20, 4
    s_cbranch_scc1 .Lt2_c
    v_lshrrev_b32 v8, 3, v1
    s_mul_i32 s28, s27, 96
    v_add_u32 v8, s28, v8
    v_lshlrev_b32 v8, 2, v8
    ds_read_b32 v20, v8 offset:0
    ds_read_b32 v21, v8 offset:32
    ds_read_b32 v22, v8 offset:64
    ds_read_b32 v23, v8 offset:96
    ds_read_b32 v24, v8 offset:128
    ds_read_b32 v25, v8 offset:160
    ds_read_b32 v26, v8 offset:192
    ds_read_b32 v27, v8 offset:224
    ds_read_b32 v28, v8 offset:256
    ds_read_b32 v29, v8 offset:288
    ds_read_b32 v30, v8 offset:320
    ds_read_b32 v31, v8 offset:352
    s_waitcnt lgkmcnt(0)
    v_lshlrev_b32 v8, 16, v64
    v_and_b32 v9, 0xffff0000, v64
    v_mul_f32 v40, v20, v8
    v_mul_f32 v41, v20, v9
    v_lshlrev_b32 v8, 16, v65
    v_and_b32 v9, 0xffff0000, v65
    v_mul_f32 v42, v20, v8
    v_mul_f32 v43, v20, v9
    v_lshlrev_b32 v8, 16, v66
    v_and_b32 v9, 0xffff0000, v66
    v_mul_f32 v44, v20, v8
    v_mul_f32 v45, v20, v9
    v_lshlrev_b32 v8, 16, v67
    v_and_b32 v9, 0xffff0000, v67
    v_mul_f32 v46, v20, v8
    v_mul_f32 v47, v20, v9
    v_lshlrev_b32 v8, 16, v68
    v_and_b32 v9, 0xffff0000, v68
    v_fmac_f32 v40, v21, v8
    v_fmac_f32 v41, v21, v9
    v_lshlrev_b32 v8, 16, v69
    v_and_b32 v9, 0xffff0000, v69
    v_fmac_f32 v42, v21, v8
    v_fmac_f32 v43, v21, v9
    v_lshlrev_b32 v8, 16, v70
    v_and_b32 v9, 0xffff0000, v70
    v_fmac_f32 v44, v21, v8
    v_fmac_f32 v45, v21, v9
    v_lshlrev_b32 v8, 16, v71
    v_and_b32 v9, 0xffff0000, v71
    v_fmac_f32 v46, v21, v8
    v_fmac_f32 v47, v21, v9
    v_lshlrev_b32 v8, 16, v72
    v_and_b32 v9, 0xffff0000, v72
    v_fmac_f32 v40, v22, v8
    v_fmac_f32 v41, v22, v9
    v_lshlrev_b32 v8, 16, v73
    v_and_b32 v9, 0xffff0000, v73
    v_fmac_f32 v42, v22, v8
    v_fmac_f32 v43, v22, v9
    v_lshlrev_b32 v8, 16, v74
    v_and_b32 v9, 0xffff0000, v74
    v_fmac_f32 v44, v22, v8
    v_fmac_f32 v45, v22, v9
    v_lshlrev_b32 v8, 16, v75
    v_and_b32 v9, 0xffff0000, v75
    v_fmac_f32 v46, v22, v8
    v_fmac_f32 v47, v22, v9
    v_lshlrev_b32 v8, 16, v76
    v_and_b32 v9, 0xffff0000, v76
    v_fmac_f32 v40, v23, v8
    v_fmac_f32 v41, v23, v9
    v_lshlrev_b32 v8, 16, v77
    v_and_b32 v9, 0xffff0000, v77
    v_fmac_f32 v42, v23, v8
    v_fmac_f32 v43, v23, v9
    v_lshlrev_b32 v8, 16, v78
    v_and_b32 v9, 0xffff0000, v78
    v_fmac_f32 v44, v23, v8
    v_fmac_f32 v45, v23, v9
    v_lshlrev_b32 v8, 16, v79
    v_and_b32 v9, 0xffff0000, v79
    v_fmac_f32 v46, v23, v8
    v_fmac_f32 v47, v23, v9
    v_lshlrev_b32 v8, 16, v80
    v_and_b32 v9, 0xffff0000, v80
    v_fmac_f32 v40, v24, v8
    v_fmac_f32 v41, v24, v9
    v_lshlrev_b32 v8, 16, v81
    v_and_b32 v9, 0xffff0000, v81
    v_fmac_f32 v42, v24, v8
    v_fmac_f32 v43, v24, v9
    v_lshlrev_b32 v8, 16, v82
    v_and_b32 v9, 0xffff0000, v82
    v_fmac_f32 v44, v24, v8
    v_fmac_f32 v45, v24, v9
    v_lshlrev_b32 v8, 16, v83
    v_and_b32 v9, 0xffff0000, v83
    v_fmac_f32 v46, v24, v8
    v_fmac_f32 v47, v24, v9
    v_lshlrev_b32 v8, 16, v84
    v_and_b32 v9, 0xffff0000, v84
    v_fmac_f32 v40, v25, v8
    v_fmac_f32 v41, v25, v9
    v_lshlrev_b32 v8, 16, v85
    v_and_b32 v9, 0xffff0000, v85
    v_fmac_f32 v42, v25, v8
    v_fmac_f32 v43, v25, v9
    v_lshlrev_b32 v8, 16, v86
    v_and_b32 v9, 0xffff0000, v86
    v_fmac_f32 v44, v25, v8
    v_fmac_f32 v45, v25, v9
    v_lshlrev_b32 v8, 16, v87
    v_and_b32 v9, 0xffff0000, v87
    v_fmac_f32 v46, v25, v8
    v_fmac_f32 v47, v25, v9
    v_lshlrev_b32 v8, 16, v88
    v_and_b32 v9, 0xffff0000, v88
    v_fmac_f32 v40, v26, v8
    v_fmac_f32 v41, v26, v9
    v_lshlrev_b32 v8, 16, v89
    v_and_b32 v9, 0xffff0000, v89
    v_fmac_f32 v42, v26, v8
    v_fmac_f32 v43, v26, v9
    v_lshlrev_b32 v8, 16, v90
    v_and_b32 v9, 0xffff0000, v90
    v_fmac_f32 v44, v26, v8
    v_fmac_f32 v45, v26, v9
    v_lshlrev_b32 v8, 16, v91
    v_and_b32 v9, 0xffff0000, v91
    v_fmac_f32 v46, v26, v8
    v_fmac_f32 v47, v26, v9
    v_lshlrev_b32 v8, 16, v92
    v_and_b32 v9, 0xffff0000, v92
    v_fmac_f32 v40, v27, v8
    v_fmac_f32 v41, v27, v9
    v_lshlrev_b32 v8, 16, v93
    v_and_b32 v9, 0xffff0000, v93
    v_fmac_f32 v42, v27, v8
    v_fmac_f32 v43, v27, v9
    v_lshlrev_b32 v8, 16, v94
    v_and_b32 v9, 0xffff0000, v94
    v_fmac_f32 v44, v27, v8
    v_fmac_f32 v45, v27, v9
    v_lshlrev_b32 v8, 16, v95
    v_and_b32 v9, 0xffff0000, v95
    v_fmac_f32 v46, v27, v8
    v_fmac_f32 v47, v27, v9
    v_lshlrev_b32 v8, 16, v96
    v_and_b32 v9, 0xffff0000, v96
    v_fmac_f32 v40, v28, v8
    v_fmac_f32 v41, v28, v9
    v_lshlrev_b32 v8, 16, v97
    v_and_b32 v9, 0xffff0000, v97
    v_fmac_f32 v42, v28, v8
    v_fmac_f32 v43, v28, v9
    v_lshlrev_b32 v8, 16, v98
    v_and_b32 v9, 0xffff0000, v98
    v_fmac_f32 v44, v28, v8
    v_fmac_f32 v45, v28, v9
    v_lshlrev_b32 v8, 16, v99
    v_and_b32 v9, 0xffff0000, v99
    v_fmac_f32 v46, v28, v8
    v_fmac_f32 v47, v28, v9
    v_lshlrev_b32 v8, 16, v100
    v_and_b32 v9, 0xffff0000, v100
    v_fmac_f32 v40, v29, v8
    v_fmac_f32 v41, v29, v9
    v_lshlrev_b32 v8, 16, v101
    v_and_b32 v9, 0xffff0000, v101
    v_fmac_f32 v42, v29, v8
    v_fmac_f32 v43, v29, v9
    v_lshlrev_b32 v8, 16, v102
    v_and_b32 v9, 0xffff0000, v102
    v_fmac_f32 v44, v29, v8
    v_fmac_f32 v45, v29, v9
    v_lshlrev_b32 v8, 16, v103
    v_and_b32 v9, 0xffff0000, v103
    v_fmac_f32 v46, v29, v8
    v_fmac_f32 v47, v29, v9
    v_lshlrev_b32 v8, 16, v104
    v_and_b32 v9, 0xffff0000, v104
    v_fmac_f32 v40, v30, v8
    v_fmac_f32 v41, v30, v9
    v_lshlrev_b32 v8, 16, v105
    v_and_b32 v9, 0xffff0000, v105
    v_fmac_f32 v42, v30, v8
    v_fmac_f32 v43, v30, v9
    v_lshlrev_b32 v8, 16, v106
    v_and_b32 v9, 0xffff0000, v106
    v_fmac_f32 v44, v30, v8
    v_fmac_f32 v45, v30, v9
    v_lshlrev_b32 v8, 16, v107
    v_and_b32 v9, 0xffff0000, v107
    v_fmac_f32 v46, v30, v8
    v_fmac_f32 v47, v30, v9
    v_lshlrev_b32 v8, 16, v108
    v_and_b32 v9, 0xffff0000, v108
    v_fmac_f32 v40, v31, v8
    v_fmac_f32 v41, v31, v9
    v_lshlrev_b32 v8, 16, v109
    v_and_b32 v9, 0xffff0000, v109
    v_fmac_f32 v42, v31, v8
    v_fmac_f32 v43, v31, v9
    v_lshlrev_b32 v8, 16, v110
    v_and_b32 v9, 0xffff0000, v110
    v_fmac_f32 v44, v31, v8
    v_fmac_f32 v45, v31, v9
    v_lshlrev_b32 v8, 16, v111
    v_and_b32 v9, 0xffff0000, v111
    v_fmac_f32 v46, v31, v8
    v_fmac_f32 v47, v31, v9
    s_nop 1
    v_permlane32_swap_b32 v40, v44
    v_permlane32_swap_b32 v41, v45
    v_permlane32_swap_b32 v42, v46
    v_permlane32_swap_b32 v43, v47
    v_add_f32 v40, v40, v44
    v_add_f32 v41, v41, v45
    v_add_f32 v42, v42, v46
    v_add_f32 v43, v43, v47
    s_nop 1
    v_permlane16_swap_b32 v40, v42
    v_permlane16_swap_b32 v41, v43
    v_add_f32 v40, v40, v42
    v_add_f32 v41, v41, v43
    s_nop 1
    v_add_f32_dpp v40, v40, v40 row_ror:8 row_mask:0xf bank_mask:0xf
    v_add_f32_dpp v41, v41, v41 row_ror:8 row_mask:0xf bank_mask:0xf
    v_lshrrev_b32 v9, 4, v1
    v_and_b32 v8, 1, v9
    v_lshrrev_b32 v9, 1, v9
    v_lshlrev_b32 v8, 3, v8
    v_lshl_add_u32 v8, v9, 4, v8
    v_and_b32 v9, 7, v1
    v_lshl_add_u32 v8, v9, 5, v8
    s_mul_i32 s28, s27, 256
    s_add_u32 s28, s28, 4096
    v_add_u32 v8, s28, v8
    s_mov_b32 exec_lo, 0xff00ff
    s_mov_b32 exec_hi, 0xff00ff
    ds_write_b64 v8, v[40:41]
    s_mov_b64 exec, -1
    s_waitcnt lgkmcnt(0)
.Lt2_c:
    s_barrier
    s_cmp_lg_u32 s20, 4
    s_cbranch_scc1 .Lend
    ds_read_b32 v20, v3 offset:4096
    ds_read_b32 v21, v3 offset:4352
    ds_read_b32 v22, v3 offset:4608
    ds_read_b32 v23, v3 offset:4864
    s_waitcnt lgkmcnt(0)
    v_add_f32 v20, v20, v21
    v_add_f32 v22, v22, v23
    v_add_f32 v20, v20, v22
    v_mov_b32 v8, 0x7fc00000
    v_cmp_eq_u32 vcc, -1, v20
    s_nop 1
    v_cndmask_b32 v20, v20, v8, vcc
    s_lshl_b32 s28, s2, 8
    s_add_u32 s28, s28, 458752
    buffer_store_dword v20, v3, s[8:11], s28 offen sc0 sc1
    s_branch .Lend
.Lt3:
    s_cmp_ge_u32 s2, 208
    s_cbranch_scc1 .Lt4
    s_mov_b32 s44, s72
    s_mov_b32 s45, s73
    s_mov_b32 s46, 1280
    s_mov_b32 s47, 0x00020000
    v_lshlrev_b32 v2, 1, v0
    buffer_load_ushort v10, v2, s[44:47], 0 offen
    buffer_load_ushort v11, v2, s[44:47], 0 offen offset:1024
    v_cmp_gt_u32 vcc, 128, v0
    v_mov_b32 v6, 2048
    s_nop 0
    v_cndmask_b32 v5, 0, v6, vcc
    v_add_u32 v5, v5, v4
    s_mov_b32 s39, 0
.poll_46:
    s_mov_b32 s29, 5120
    buffer_load_dword v12, v4, s[8:11], s29 offen sc1
    buffer_load_dword v13, v5, s[8:11], s29 offen sc1
    s_mov_b32 s29, 458752
    buffer_load_dword v20, v4, s[8:11], s29 offen sc1
    buffer_load_dword v170, v5, s[8:11], s29 offen sc1
    s_mov_b32 s29, 461312
    buffer_load_dword v21, v4, s[8:11], s29 offen sc1
    buffer_load_dword v171, v5, s[8:11], s29 offen sc1
    s_mov_b32 s29, 463872
    buffer_load_dword v22, v4, s[8:11], s29 offen sc1
    buffer_load_dword v172, v5, s[8:11], s29 offen sc1
    s_mov_b32 s29, 466432
    buffer_load_dword v23, v4, s[8:11], s29 offen sc1
    buffer_load_dword v173, v5, s[8:11], s29 offen sc1
    s_mov_b32 s29, 468992
    buffer_load_dword v24, v4, s[8:11], s29 offen sc1
    buffer_load_dword v174, v5, s[8:11], s29 offen sc1
    s_mov_b32 s29, 471552
    buffer_load_dword v25, v4, s[8:11], s29 offen sc1
    buffer_load_dword v175, v5, s[8:11], s29 offen sc1
    s_mov_b32 s29, 474112
    buffer_load_dword v26, v4, s[8:11], s29 offen sc1
    buffer_load_dword v176, v5, s[8:11], s29 offen sc1
    s_mov_b32 s29, 476672
    buffer_load_dword v27, v4, s[8:11], s29 offen sc1
    buffer_load_dword v177, v5, s[8:11], s29 offen sc1
    s_mov_b32 s29, 479232
    buffer_load_dword v28, v4, s[8:11], s29 offen sc1
    buffer_load_dword v178, v5, s[8:11], s29 offen sc1
    s_mov_b32 s29, 481792
    buffer_load_dword v29, v4, s[8:11], s29 offen sc1
    buffer_load_dword v179, v5, s[8:11], s29 offen sc1
    s_mov_b32 s29, 484352
    buffer_load_dword v30, v4, s[8:11], s29 offen sc1
    buffer_load_dword v180, v5, s[8:11], s29 offen sc1
    s_mov_b32 s29, 486912
    buffer_load_dword v31, v4, s[8:11], s29 offen sc1
    buffer_load_dword v181, v5, s[8:11], s29 offen sc1
    s_mov_b32 s29, 489472
    buffer_load_dword v32, v4, s[8:11], s29 offen sc1
    buffer_load_dword v182, v5, s[8:11], s29 offen sc1
    s_mov_b32 s29, 492032
    buffer_load_dword v33, v4, s[8:11], s29 offen sc1
    buffer_load_dword v183, v5, s[8:11], s29 offen sc1
    s_mov_b32 s29, 494592
    buffer_load_dword v34, v4, s[8:11], s29 offen sc1
    buffer_load_dword v184, v5, s[8:11], s29 offen sc1
    s_mov_b32 s29, 497152
    buffer_load_dword v35, v4, s[8:11], s29 offen sc1
    buffer_load_dword v185, v5, s[8:11], s29 offen sc1
    s_waitcnt vmcnt(0)
    v_mov_b32 v53, v12
    v_max3_u32 v53, v53, v13, v20
    v_max3_u32 v53, v53, v21, v22
    v_max3_u32 v53, v53, v23, v24
    v_max3_u32 v53, v53, v25, v26
    v_max3_u32 v53, v53, v27, v28
    v_max3_u32 v53, v53, v29, v30
    v_max3_u32 v53, v53, v31, v32
    v_max3_u32 v53, v53, v33, v34
    v_max3_u32 v53, v53, v35, v170
    v_max3_u32 v53, v53, v171, v172
    v_max3_u32 v53, v53, v173, v174
    v_max3_u32 v53, v53, v175, v176
    v_max3_u32 v53, v53, v177, v178
    v_max3_u32 v53, v53, v179, v180
    v_max3_u32 v53, v53, v181, v182
    v_max3_u32 v53, v53, v183, v184
    v_max_u32 v53, v53, v185
    v_cmp_eq_u32 vcc, -1, v53
    s_cbranch_vccz .polld_47
    s_add_u32 s39, s39, 1
    s_cmp_gt_u32 s39, 400000
    s_cbranch_scc1 .polld_47
    s_sleep 1
    s_branch .poll_46
.polld_47:
    v_add_f32 v20, v20, v21
    v_add_f32 v170, v170, v171
    v_add_f32 v20, v20, v22
    v_add_f32 v170, v170, v172
    v_add_f32 v20, v20, v23
    v_add_f32 v170, v170, v173
    v_add_f32 v20, v20, v24
    v_add_f32 v170, v170, v174
    v_add_f32 v20, v20, v25
    v_add_f32 v170, v170, v175
    v_add_f32 v20, v20, v26
    v_add_f32 v170, v170, v176
    v_add_f32 v20, v20, v27
    v_add_f32 v170, v170, v177
    v_add_f32 v20, v20, v28
    v_add_f32 v170, v170, v178
    v_add_f32 v20, v20, v29
    v_add_f32 v170, v170, v179
    v_add_f32 v20, v20, v30
    v_add_f32 v170, v170, v180
    v_add_f32 v20, v20, v31
    v_add_f32 v170, v170, v181
    v_add_f32 v20, v20, v32
    v_add_f32 v170, v170, v182
    v_add_f32 v20, v20, v33
    v_add_f32 v170, v170, v183
    v_add_f32 v20, v20, v34
    v_add_f32 v170, v170, v184
    v_add_f32 v20, v20, v35
    v_add_f32 v170, v170, v185
    v_mov_b32 v21, v170
    v_cvt_pk_bf16_f32 v8, v20, v20
    v_lshlrev_b32 v20, 16, v8
    v_mul_f32 v20, v20, v12
    v_cvt_pk_bf16_f32 v8, v20, v20
    v_lshlrev_b32 v20, 16, v8
    v_lshlrev_b32 v10, 16, v10
    v_add_f32 v10, v10, v20
    v_cvt_pk_bf16_f32 v8, v10, v10
    v_lshlrev_b32 v10, 16, v8
    ds_write_b32 v4, v10 offset:0
    v_cvt_pk_bf16_f32 v8, v21, v21
    v_lshlrev_b32 v21, 16, v8
    v_mul_f32 v21, v21, v13
    v_cvt_pk_bf16_f32 v8, v21, v21
    v_lshlrev_b32 v21, 16, v8
    v_lshlrev_b32 v11, 16, v11
    v_add_f32 v11, v11, v21
    v_cvt_pk_bf16_f32 v8, v11, v11
    v_lshlrev_b32 v11, 16, v8
    ds_write_b32 v4, v11 offset:2048
    s_waitcnt lgkmcnt(0)
    s_barrier
    s_cmp_lt_u32 s20, 4
    s_cbranch_scc1 .Lt3_c
    ds_read_b32 v28, v3 offset:0
    ds_read_b32 v29, v3 offset:256
    ds_read_b32 v30, v3 offset:512
    ds_read_b32 v31, v3 offset:768
    ds_read_b32 v32, v3 offset:1024
    ds_read_b32 v33, v3 offset:1280
    ds_read_b32 v34, v3 offset:1536
    ds_read_b32 v35, v3 offset:1792
    ds_read_b32 v36, v3 offset:2048
    ds_read_b32 v37, v3 offset:2304
    v_lshrrev_b32 v8, 2, v1
    s_mul_i32 s28, s27, 160
    v_add_u32 v8, s28, v8
    v_lshlrev_b32 v8, 2, v8
    ds_read_b32 v16, v8 offset:0
    ds_read_b32 v17, v8 offset:64
    ds_read_b32 v18, v8 offset:128
    ds_read_b32 v19, v8 offset:192
    ds_read_b32 v20, v8 offset:256
    ds_read_b32 v21, v8 offset:320
    ds_read_b32 v22, v8 offset:384
    ds_read_b32 v23, v8 offset:448
    ds_read_b32 v24, v8 offset:512
    ds_read_b32 v25, v8 offset:576
    s_waitcnt lgkmcnt(0)
    v_add_f32 v8, v28, v29
    v_add_f32 v8, v8, v30
    v_add_f32 v8, v8, v31
    v_add_f32 v8, v8, v32
    v_add_f32 v8, v8, v33
    v_add_f32 v8, v8, v34
    v_add_f32 v8, v8, v35
    v_add_f32 v8, v8, v36
    v_add_f32 v8, v8, v37
    s_nop 1
    v_add_f32_dpp v8, v8, v8 quad_perm:[1,0,3,2] row_mask:0xf bank_mask:0xf
    s_nop 1
    v_add_f32_dpp v8, v8, v8 quad_perm:[2,3,0,1] row_mask:0xf bank_mask:0xf
    s_nop 1
    v_add_f32_dpp v8, v8, v8 row_half_mirror row_mask:0xf bank_mask:0xf
    s_nop 1
    v_add_f32_dpp v8, v8, v8 row_mirror row_mask:0xf bank_mask:0xf
    s_nop 1
    v_readlane_b32 s40, v8, 0
    v_readlane_b32 s41, v8, 16
    v_readlane_b32 s42, v8, 32
    v_readlane_b32 s43, v8, 48
    s_nop 1
    v_mov_b32 v8, s40
    v_add_f32 v8, s41, v8
    v_add_f32 v8, s42, v8
    v_add_f32 v8, s43, v8
    v_mul_f32 v8, 0x3acccccd, v8
    v_sub_f32 v10, v28, v8
    v_mul_f32 v9, v10, v10
    v_sub_f32 v10, v29, v8
    v_fma_f32 v9, v10, v10, v9
    v_sub_f32 v10, v30, v8
    v_fma_f32 v9, v10, v10, v9
    v_sub_f32 v10, v31, v8
    v_fma_f32 v9, v10, v10, v9
    v_sub_f32 v10, v32, v8
    v_fma_f32 v9, v10, v10, v9
    v_sub_f32 v10, v33, v8
    v_fma_f32 v9, v10, v10, v9
    v_sub_f32 v10, v34, v8
    v_fma_f32 v9, v10, v10, v9
    v_sub_f32 v10, v35, v8
    v_fma_f32 v9, v10, v10, v9
    v_sub_f32 v10, v36, v8
    v_fma_f32 v9, v10, v10, v9
    v_sub_f32 v10, v37, v8
    v_fma_f32 v9, v10, v10, v9
    s_nop 1
    v_add_f32_dpp v9, v9, v9 quad_perm:[1,0,3,2] row_mask:0xf bank_mask:0xf
    s_nop 1
    v_add_f32_dpp v9, v9, v9 quad_perm:[2,3,0,1] row_mask:0xf bank_mask:0xf
    s_nop 1
    v_add_f32_dpp v9, v9, v9 row_half_mirror row_mask:0xf bank_mask:0xf
    s_nop 1
    v_add_f32_dpp v9, v9, v9 row_mirror row_mask:0xf bank_mask:0xf
    s_nop 1
    v_readlane_b32 s40, v9, 0
    v_readlane_b32 s41, v9, 16
    v_readlane_b32 s42, v9, 32
    v_readlane_b32 s43, v9, 48
    s_nop 1
    v_mov_b32 v9, s40
    v_add_f32 v9, s41, v9
    v_add_f32 v9, s42, v9
    v_add_f32 v9, s43, v9
    v_mul_f32 v9, 0x3acccccd, v9
    v_cvt_pk_bf16_f32 v10, v8, v8
    v_lshlrev_b32 v8, 16, v10
    v_cvt_pk_bf16_f32 v10, v9, v9
    v_lshlrev_b32 v9, 16, v10
    v_add_f32 v9, 0x3727c5ac, v9
    v_cvt_pk_bf16_f32 v10, v9, v9
    v_lshlrev_b32 v9, 16, v10
    v_sqrt_f32 v9, v9
    s_nop 0
    v_cvt_pk_bf16_f32 v10, v9, v9
    v_lshlrev_b32 v9, 16, v10
    v_sub_f32 v16, v16, v8
    v_cvt_pk_bf16_f32 v10, v16, v16
    v_lshlrev_b32 v16, 16, v10
    v_mov_b32 v11, v9
    v_rcp_f32 v12, v11
    s_nop 0
    v_mul_f32 v13, v16, v12
    v_fma_f32 v11, -v13, v11, v16
    v_fma_f32 v16, v11, v12, v13
    v_cvt_pk_bf16_f32 v10, v16, v16
    v_lshlrev_b32 v16, 16, v10
    v_mul_f32 v16, v16, v154
    v_cvt_pk_bf16_f32 v10, v16, v16
    v_lshlrev_b32 v16, 16, v10
    v_add_f32 v16, v16, v144
    v_cvt_pk_bf16_f32 v10, v16, v16
    v_lshlrev_b32 v16, 16, v10
    v_sub_f32 v17, v17, v8
    v_cvt_pk_bf16_f32 v10, v17, v17
    v_lshlrev_b32 v17, 16, v10
    v_mov_b32 v11, v9
    v_rcp_f32 v12, v11
    s_nop 0
    v_mul_f32 v13, v17, v12
    v_fma_f32 v11, -v13, v11, v17
    v_fma_f32 v17, v11, v12, v13
    v_cvt_pk_bf16_f32 v10, v17, v17
    v_lshlrev_b32 v17, 16, v10
    v_mul_f32 v17, v17, v155
    v_cvt_pk_bf16_f32 v10, v17, v17
    v_lshlrev_b32 v17, 16, v10
    v_add_f32 v17, v17, v145
    v_cvt_pk_bf16_f32 v10, v17, v17
    v_lshlrev_b32 v17, 16, v10
    v_sub_f32 v18, v18, v8
    v_cvt_pk_bf16_f32 v10, v18, v18
    v_lshlrev_b32 v18, 16, v10
    v_mov_b32 v11, v9
    v_rcp_f32 v12, v11
    s_nop 0
    v_mul_f32 v13, v18, v12
    v_fma_f32 v11, -v13, v11, v18
    v_fma_f32 v18, v11, v12, v13
    v_cvt_pk_bf16_f32 v10, v18, v18
    v_lshlrev_b32 v18, 16, v10
    v_mul_f32 v18, v18, v156
    v_cvt_pk_bf16_f32 v10, v18, v18
    v_lshlrev_b32 v18, 16, v10
    v_add_f32 v18, v18, v146
    v_cvt_pk_bf16_f32 v10, v18, v18
    v_lshlrev_b32 v18, 16, v10
    v_sub_f32 v19, v19, v8
    v_cvt_pk_bf16_f32 v10, v19, v19
    v_lshlrev_b32 v19, 16, v10
    v_mov_b32 v11, v9
    v_rcp_f32 v12, v11
    s_nop 0
    v_mul_f32 v13, v19, v12
    v_fma_f32 v11, -v13, v11, v19
    v_fma_f32 v19, v11, v12, v13
    v_cvt_pk_bf16_f32 v10, v19, v19
    v_lshlrev_b32 v19, 16, v10
    v_mul_f32 v19, v19, v157
    v_cvt_pk_bf16_f32 v10, v19, v19
    v_lshlrev_b32 v19, 16, v10
    v_add_f32 v19, v19, v147
    v_cvt_pk_bf16_f32 v10, v19, v19
    v_lshlrev_b32 v19, 16, v10
    v_sub_f32 v20, v20, v8
    v_cvt_pk_bf16_f32 v10, v20, v20
    v_lshlrev_b32 v20, 16, v10
    v_mov_b32 v11, v9
    v_rcp_f32 v12, v11
    s_nop 0
    v_mul_f32 v13, v20, v12
    v_fma_f32 v11, -v13, v11, v20
    v_fma_f32 v20, v11, v12, v13
    v_cvt_pk_bf16_f32 v10, v20, v20
    v_lshlrev_b32 v20, 16, v10
    v_mul_f32 v20, v20, v158
    v_cvt_pk_bf16_f32 v10, v20, v20
    v_lshlrev_b32 v20, 16, v10
    v_add_f32 v20, v20, v148
    v_cvt_pk_bf16_f32 v10, v20, v20
    v_lshlrev_b32 v20, 16, v10
    v_sub_f32 v21, v21, v8
    v_cvt_pk_bf16_f32 v10, v21, v21
    v_lshlrev_b32 v21, 16, v10
    v_mov_b32 v11, v9
    v_rcp_f32 v12, v11
    s_nop 0
    v_mul_f32 v13, v21, v12
    v_fma_f32 v11, -v13, v11, v21
    v_fma_f32 v21, v11, v12, v13
    v_cvt_pk_bf16_f32 v10, v21, v21
    v_lshlrev_b32 v21, 16, v10
    v_mul_f32 v21, v21, v159
    v_cvt_pk_bf16_f32 v10, v21, v21
    v_lshlrev_b32 v21, 16, v10
    v_add_f32 v21, v21, v149
    v_cvt_pk_bf16_f32 v10, v21, v21
    v_lshlrev_b32 v21, 16, v10
    v_sub_f32 v22, v22, v8
    v_cvt_pk_bf16_f32 v10, v22, v22
    v_lshlrev_b32 v22, 16, v10
    v_mov_b32 v11, v9
    v_rcp_f32 v12, v11
    s_nop 0
    v_mul_f32 v13, v22, v12
    v_fma_f32 v11, -v13, v11, v22
    v_fma_f32 v22, v11, v12, v13
    v_cvt_pk_bf16_f32 v10, v22, v22
    v_lshlrev_b32 v22, 16, v10
    v_mul_f32 v22, v22, v160
    v_cvt_pk_bf16_f32 v10, v22, v22
    v_lshlrev_b32 v22, 16, v10
    v_add_f32 v22, v22, v150
    v_cvt_pk_bf16_f32 v10, v22, v22
    v_lshlrev_b32 v22, 16, v10
    v_sub_f32 v23, v23, v8
    v_cvt_pk_bf16_f32 v10, v23, v23
    v_lshlrev_b32 v23, 16, v10
    v_mov_b32 v11, v9
    v_rcp_f32 v12, v11
    s_nop 0
    v_mul_f32 v13, v23, v12
    v_fma_f32 v11, -v13, v11, v23
    v_fma_f32 v23, v11, v12, v13
    v_cvt_pk_bf16_f32 v10, v23, v23
    v_lshlrev_b32 v23, 16, v10
    v_mul_f32 v23, v23, v161
    v_cvt_pk_bf16_f32 v10, v23, v23
    v_lshlrev_b32 v23, 16, v10
    v_add_f32 v23, v23, v151
    v_cvt_pk_bf16_f32 v10, v23, v23
    v_lshlrev_b32 v23, 16, v10
    v_sub_f32 v24, v24, v8
    v_cvt_pk_bf16_f32 v10, v24, v24
    v_lshlrev_b32 v24, 16, v10
    v_mov_b32 v11, v9
    v_rcp_f32 v12, v11
    s_nop 0
    v_mul_f32 v13, v24, v12
    v_fma_f32 v11, -v13, v11, v24
    v_fma_f32 v24, v11, v12, v13
    v_cvt_pk_bf16_f32 v10, v24, v24
    v_lshlrev_b32 v24, 16, v10
    v_mul_f32 v24, v24, v162
    v_cvt_pk_bf16_f32 v10, v24, v24
    v_lshlrev_b32 v24, 16, v10
    v_add_f32 v24, v24, v152
    v_cvt_pk_bf16_f32 v10, v24, v24
    v_lshlrev_b32 v24, 16, v10
    v_sub_f32 v25, v25, v8
    v_cvt_pk_bf16_f32 v10, v25, v25
    v_lshlrev_b32 v25, 16, v10
    v_mov_b32 v11, v9
    v_rcp_f32 v12, v11
    s_nop 0
    v_mul_f32 v13, v25, v12
    v_fma_f32 v11, -v13, v11, v25
    v_fma_f32 v25, v11, v12, v13
    v_cvt_pk_bf16_f32 v10, v25, v25
    v_lshlrev_b32 v25, 16, v10
    v_mul_f32 v25, v25, v163
    v_cvt_pk_bf16_f32 v10, v25, v25
    v_lshlrev_b32 v25, 16, v10
    v_add_f32 v25, v25, v153
    v_cvt_pk_bf16_f32 v10, v25, v25
    v_lshlrev_b32 v25, 16, v10
    v_lshlrev_b32 v8, 16, v64
    v_and_b32 v9, 0xffff0000, v64
    v_mul_f32 v40, v16, v8
    v_mul_f32 v41, v16, v9
    v_lshlrev_b32 v8, 16, v65
    v_and_b32 v9, 0xffff0000, v65
    v_mul_f32 v42, v16, v8
    v_mul_f32 v43, v16, v9
    v_lshlrev_b32 v8, 16, v66
    v_and_b32 v9, 0xffff0000, v66
    v_mul_f32 v44, v16, v8
    v_mul_f32 v45, v16, v9
    v_lshlrev_b32 v8, 16, v67
    v_and_b32 v9, 0xffff0000, v67
    v_mul_f32 v46, v16, v8
    v_mul_f32 v47, v16, v9
    v_lshlrev_b32 v8, 16, v68
    v_and_b32 v9, 0xffff0000, v68
    v_fmac_f32 v40, v17, v8
    v_fmac_f32 v41, v17, v9
    v_lshlrev_b32 v8, 16, v69
    v_and_b32 v9, 0xffff0000, v69
    v_fmac_f32 v42, v17, v8
    v_fmac_f32 v43, v17, v9
    v_lshlrev_b32 v8, 16, v70
    v_and_b32 v9, 0xffff0000, v70
    v_fmac_f32 v44, v17, v8
    v_fmac_f32 v45, v17, v9
    v_lshlrev_b32 v8, 16, v71
    v_and_b32 v9, 0xffff0000, v71
    v_fmac_f32 v46, v17, v8
    v_fmac_f32 v47, v17, v9
    v_lshlrev_b32 v8, 16, v72
    v_and_b32 v9, 0xffff0000, v72
    v_fmac_f32 v40, v18, v8
    v_fmac_f32 v41, v18, v9
    v_lshlrev_b32 v8, 16, v73
    v_and_b32 v9, 0xffff0000, v73
    v_fmac_f32 v42, v18, v8
    v_fmac_f32 v43, v18, v9
    v_lshlrev_b32 v8, 16, v74
    v_and_b32 v9, 0xffff0000, v74
    v_fmac_f32 v44, v18, v8
    v_fmac_f32 v45, v18, v9
    v_lshlrev_b32 v8, 16, v75
    v_and_b32 v9, 0xffff0000, v75
    v_fmac_f32 v46, v18, v8
    v_fmac_f32 v47, v18, v9
    v_lshlrev_b32 v8, 16, v76
    v_and_b32 v9, 0xffff0000, v76
    v_fmac_f32 v40, v19, v8
    v_fmac_f32 v41, v19, v9
    v_lshlrev_b32 v8, 16, v77
    v_and_b32 v9, 0xffff0000, v77
    v_fmac_f32 v42, v19, v8
    v_fmac_f32 v43, v19, v9
    v_lshlrev_b32 v8, 16, v78
    v_and_b32 v9, 0xffff0000, v78
    v_fmac_f32 v44, v19, v8
    v_fmac_f32 v45, v19, v9
    v_lshlrev_b32 v8, 16, v79
    v_and_b32 v9, 0xffff0000, v79
    v_fmac_f32 v46, v19, v8
    v_fmac_f32 v47, v19, v9
    v_lshlrev_b32 v8, 16, v80
    v_and_b32 v9, 0xffff0000, v80
    v_fmac_f32 v40, v20, v8
    v_fmac_f32 v41, v20, v9
    v_lshlrev_b32 v8, 16, v81
    v_and_b32 v9, 0xffff0000, v81
    v_fmac_f32 v42, v20, v8
    v_fmac_f32 v43, v20, v9
    v_lshlrev_b32 v8, 16, v82
    v_and_b32 v9, 0xffff0000, v82
    v_fmac_f32 v44, v20, v8
    v_fmac_f32 v45, v20, v9
    v_lshlrev_b32 v8, 16, v83
    v_and_b32 v9, 0xffff0000, v83
    v_fmac_f32 v46, v20, v8
    v_fmac_f32 v47, v20, v9
    v_lshlrev_b32 v8, 16, v84
    v_and_b32 v9, 0xffff0000, v84
    v_fmac_f32 v40, v21, v8
    v_fmac_f32 v41, v21, v9
    v_lshlrev_b32 v8, 16, v85
    v_and_b32 v9, 0xffff0000, v85
    v_fmac_f32 v42, v21, v8
    v_fmac_f32 v43, v21, v9
    v_lshlrev_b32 v8, 16, v86
    v_and_b32 v9, 0xffff0000, v86
    v_fmac_f32 v44, v21, v8
    v_fmac_f32 v45, v21, v9
    v_lshlrev_b32 v8, 16, v87
    v_and_b32 v9, 0xffff0000, v87
    v_fmac_f32 v46, v21, v8
    v_fmac_f32 v47, v21, v9
    v_lshlrev_b32 v8, 16, v88
    v_and_b32 v9, 0xffff0000, v88
    v_fmac_f32 v40, v22, v8
    v_fmac_f32 v41, v22, v9
    v_lshlrev_b32 v8, 16, v89
    v_and_b32 v9, 0xffff0000, v89
    v_fmac_f32 v42, v22, v8
    v_fmac_f32 v43, v22, v9
    v_lshlrev_b32 v8, 16, v90
    v_and_b32 v9, 0xffff0000, v90
    v_fmac_f32 v44, v22, v8
    v_fmac_f32 v45, v22, v9
    v_lshlrev_b32 v8, 16, v91
    v_and_b32 v9, 0xffff0000, v91
    v_fmac_f32 v46, v22, v8
    v_fmac_f32 v47, v22, v9
    v_lshlrev_b32 v8, 16, v92
    v_and_b32 v9, 0xffff0000, v92
    v_fmac_f32 v40, v23, v8
    v_fmac_f32 v41, v23, v9
    v_lshlrev_b32 v8, 16, v93
    v_and_b32 v9, 0xffff0000, v93
    v_fmac_f32 v42, v23, v8
    v_fmac_f32 v43, v23, v9
    v_lshlrev_b32 v8, 16, v94
    v_and_b32 v9, 0xffff0000, v94
    v_fmac_f32 v44, v23, v8
    v_fmac_f32 v45, v23, v9
    v_lshlrev_b32 v8, 16, v95
    v_and_b32 v9, 0xffff0000, v95
    v_fmac_f32 v46, v23, v8
    v_fmac_f32 v47, v23, v9
    v_lshlrev_b32 v8, 16, v96
    v_and_b32 v9, 0xffff0000, v96
    v_fmac_f32 v40, v24, v8
    v_fmac_f32 v41, v24, v9
    v_lshlrev_b32 v8, 16, v97
    v_and_b32 v9, 0xffff0000, v97
    v_fmac_f32 v42, v24, v8
    v_fmac_f32 v43, v24, v9
    v_lshlrev_b32 v8, 16, v98
    v_and_b32 v9, 0xffff0000, v98
    v_fmac_f32 v44, v24, v8
    v_fmac_f32 v45, v24, v9
    v_lshlrev_b32 v8, 16, v99
    v_and_b32 v9, 0xffff0000, v99
    v_fmac_f32 v46, v24, v8
    v_fmac_f32 v47, v24, v9
    v_lshlrev_b32 v8, 16, v100
    v_and_b32 v9, 0xffff0000, v100
    v_fmac_f32 v40, v25, v8
    v_fmac_f32 v41, v25, v9
    v_lshlrev_b32 v8, 16, v101
    v_and_b32 v9, 0xffff0000, v101
    v_fmac_f32 v42, v25, v8
    v_fmac_f32 v43, v25, v9
    v_lshlrev_b32 v8, 16, v102
    v_and_b32 v9, 0xffff0000, v102
    v_fmac_f32 v44, v25, v8
    v_fmac_f32 v45, v25, v9
    v_lshlrev_b32 v8, 16, v103
    v_and_b32 v9, 0xffff0000, v103
    v_fmac_f32 v46, v25, v8
    v_fmac_f32 v47, v25, v9
    v_lshlrev_b32 v8, 16, v104
    v_and_b32 v9, 0xffff0000, v104
    v_mul_f32 v32, v16, v8
    v_mul_f32 v33, v16, v9
    v_lshlrev_b32 v8, 16, v105
    v_and_b32 v9, 0xffff0000, v105
    v_mul_f32 v34, v16, v8
    v_mul_f32 v35, v16, v9
    v_lshlrev_b32 v8, 16, v106
    v_and_b32 v9, 0xffff0000, v106
    v_mul_f32 v36, v16, v8
    v_mul_f32 v37, v16, v9
    v_lshlrev_b32 v8, 16, v107
    v_and_b32 v9, 0xffff0000, v107
    v_mul_f32 v38, v16, v8
    v_mul_f32 v39, v16, v9
    v_lshlrev_b32 v8, 16, v108
    v_and_b32 v9, 0xffff0000, v108
    v_fmac_f32 v32, v17, v8
    v_fmac_f32 v33, v17, v9
    v_lshlrev_b32 v8, 16, v109
    v_and_b32 v9, 0xffff0000, v109
    v_fmac_f32 v34, v17, v8
    v_fmac_f32 v35, v17, v9
    v_lshlrev_b32 v8, 16, v110
    v_and_b32 v9, 0xffff0000, v110
    v_fmac_f32 v36, v17, v8
    v_fmac_f32 v37, v17, v9
    v_lshlrev_b32 v8, 16, v111
    v_and_b32 v9, 0xffff0000, v111
    v_fmac_f32 v38, v17, v8
    v_fmac_f32 v39, v17, v9
    v_lshlrev_b32 v8, 16, v112
    v_and_b32 v9, 0xffff0000, v112
    v_fmac_f32 v32, v18, v8
    v_fmac_f32 v33, v18, v9
    v_lshlrev_b32 v8, 16, v113
    v_and_b32 v9, 0xffff0000, v113
    v_fmac_f32 v34, v18, v8
    v_fmac_f32 v35, v18, v9
    v_lshlrev_b32 v8, 16, v114
    v_and_b32 v9, 0xffff0000, v114
    v_fmac_f32 v36, v18, v8
    v_fmac_f32 v37, v18, v9
    v_lshlrev_b32 v8, 16, v115
    v_and_b32 v9, 0xffff0000, v115
    v_fmac_f32 v38, v18, v8
    v_fmac_f32 v39, v18, v9
    v_lshlrev_b32 v8, 16, v116
    v_and_b32 v9, 0xffff0000, v116
    v_fmac_f32 v32, v19, v8
    v_fmac_f32 v33, v19, v9
    v_lshlrev_b32 v8, 16, v117
    v_and_b32 v9, 0xffff0000, v117
    v_fmac_f32 v34, v19, v8
    v_fmac_f32 v35, v19, v9
    v_lshlrev_b32 v8, 16, v118
    v_and_b32 v9, 0xffff0000, v118
    v_fmac_f32 v36, v19, v8
    v_fmac_f32 v37, v19, v9
    v_lshlrev_b32 v8, 16, v119
    v_and_b32 v9, 0xffff0000, v119
    v_fmac_f32 v38, v19, v8
    v_fmac_f32 v39, v19, v9
    v_lshlrev_b32 v8, 16, v120
    v_and_b32 v9, 0xffff0000, v120
    v_fmac_f32 v32, v20, v8
    v_fmac_f32 v33, v20, v9
    v_lshlrev_b32 v8, 16, v121
    v_and_b32 v9, 0xffff0000, v121
    v_fmac_f32 v34, v20, v8
    v_fmac_f32 v35, v20, v9
    v_lshlrev_b32 v8, 16, v122
    v_and_b32 v9, 0xffff0000, v122
    v_fmac_f32 v36, v20, v8
    v_fmac_f32 v37, v20, v9
    v_lshlrev_b32 v8, 16, v123
    v_and_b32 v9, 0xffff0000, v123
    v_fmac_f32 v38, v20, v8
    v_fmac_f32 v39, v20, v9
    v_lshlrev_b32 v8, 16, v124
    v_and_b32 v9, 0xffff0000, v124
    v_fmac_f32 v32, v21, v8
    v_fmac_f32 v33, v21, v9
    v_lshlrev_b32 v8, 16, v125
    v_and_b32 v9, 0xffff0000, v125
    v_fmac_f32 v34, v21, v8
    v_fmac_f32 v35, v21, v9
    v_lshlrev_b32 v8, 16, v126
    v_and_b32 v9, 0xffff0000, v126
    v_fmac_f32 v36, v21, v8
    v_fmac_f32 v37, v21, v9
    v_lshlrev_b32 v8, 16, v127
    v_and_b32 v9, 0xffff0000, v127
    v_fmac_f32 v38, v21, v8
    v_fmac_f32 v39, v21, v9
    v_lshlrev_b32 v8, 16, v128
    v_and_b32 v9, 0xffff0000, v128
    v_fmac_f32 v32, v22, v8
    v_fmac_f32 v33, v22, v9
    v_lshlrev_b32 v8, 16, v129
    v_and_b32 v9, 0xffff0000, v129
    v_fmac_f32 v34, v22, v8
    v_fmac_f32 v35, v22, v9
    v_lshlrev_b32 v8, 16, v130
    v_and_b32 v9, 0xffff0000, v130
    v_fmac_f32 v36, v22, v8
    v_fmac_f32 v37, v22, v9
    v_lshlrev_b32 v8, 16, v131
    v_and_b32 v9, 0xffff0000, v131
    v_fmac_f32 v38, v22, v8
    v_fmac_f32 v39, v22, v9
    v_lshlrev_b32 v8, 16, v132
    v_and_b32 v9, 0xffff0000, v132
    v_fmac_f32 v32, v23, v8
    v_fmac_f32 v33, v23, v9
    v_lshlrev_b32 v8, 16, v133
    v_and_b32 v9, 0xffff0000, v133
    v_fmac_f32 v34, v23, v8
    v_fmac_f32 v35, v23, v9
    v_lshlrev_b32 v8, 16, v134
    v_and_b32 v9, 0xffff0000, v134
    v_fmac_f32 v36, v23, v8
    v_fmac_f32 v37, v23, v9
    v_lshlrev_b32 v8, 16, v135
    v_and_b32 v9, 0xffff0000, v135
    v_fmac_f32 v38, v23, v8
    v_fmac_f32 v39, v23, v9
    v_lshlrev_b32 v8, 16, v136
    v_and_b32 v9, 0xffff0000, v136
    v_fmac_f32 v32, v24, v8
    v_fmac_f32 v33, v24, v9
    v_lshlrev_b32 v8, 16, v137
    v_and_b32 v9, 0xffff0000, v137
    v_fmac_f32 v34, v24, v8
    v_fmac_f32 v35, v24, v9
    v_lshlrev_b32 v8, 16, v138
    v_and_b32 v9, 0xffff0000, v138
    v_fmac_f32 v36, v24, v8
    v_fmac_f32 v37, v24, v9
    v_lshlrev_b32 v8, 16, v139
    v_and_b32 v9, 0xffff0000, v139
    v_fmac_f32 v38, v24, v8
    v_fmac_f32 v39, v24, v9
    v_lshlrev_b32 v8, 16, v140
    v_and_b32 v9, 0xffff0000, v140
    v_fmac_f32 v32, v25, v8
    v_fmac_f32 v33, v25, v9
    v_lshlrev_b32 v8, 16, v141
    v_and_b32 v9, 0xffff0000, v141
    v_fmac_f32 v34, v25, v8
    v_fmac_f32 v35, v25, v9
    v_lshlrev_b32 v8, 16, v142
    v_and_b32 v9, 0xffff0000, v142
    v_fmac_f32 v36, v25, v8
    v_fmac_f32 v37, v25, v9
    v_lshlrev_b32 v8, 16, v143
    v_and_b32 v9, 0xffff0000, v143
    v_fmac_f32 v38, v25, v8
    v_fmac_f32 v39, v25, v9
    s_nop 1
    v_permlane32_swap_b32 v40, v44
    v_permlane32_swap_b32 v41, v45
    v_permlane32_swap_b32 v42, v46
    v_permlane32_swap_b32 v43, v47
    v_add_f32 v40, v40, v44
    v_add_f32 v41, v41, v45
    v_add_f32 v42, v42, v46
    v_add_f32 v43, v43, v47
    s_nop 1
    v_permlane16_swap_b32 v40, v42
    v_permlane16_swap_b32 v41, v43
    v_add_f32 v40, v40, v42
    v_add_f32 v41, v41, v43
    s_nop 1
    v_add_f32_dpp v40, v40, v40 row_ror:4 row_mask:0xf bank_mask:0xf
    v_add_f32_dpp v41, v41, v41 row_ror:4 row_mask:0xf bank_mask:0xf
    s_nop 1
    v_add_f32_dpp v40, v40, v40 row_ror:8 row_mask:0xf bank_mask:0xf
    v_add_f32_dpp v41, v41, v41 row_ror:8 row_mask:0xf bank_mask:0xf
    s_nop 1
    v_permlane32_swap_b32 v32, v36
    v_permlane32_swap_b32 v33, v37
    v_permlane32_swap_b32 v34, v38
    v_permlane32_swap_b32 v35, v39
    v_add_f32 v32, v32, v36
    v_add_f32 v33, v33, v37
    v_add_f32 v34, v34, v38
    v_add_f32 v35, v35, v39
    s_nop 1
    v_permlane16_swap_b32 v32, v34
    v_permlane16_swap_b32 v33, v35
    v_add_f32 v32, v32, v34
    v_add_f32 v33, v33, v35
    s_nop 1
    v_add_f32_dpp v32, v32, v32 row_ror:4 row_mask:0xf bank_mask:0xf
    v_add_f32_dpp v33, v33, v33 row_ror:4 row_mask:0xf bank_mask:0xf
    s_nop 1
    v_add_f32_dpp v32, v32, v32 row_ror:8 row_mask:0xf bank_mask:0xf
    v_add_f32_dpp v33, v33, v33 row_ror:8 row_mask:0xf bank_mask:0xf
    v_lshrrev_b32 v9, 4, v1
    v_and_b32 v8, 1, v9
    v_lshrrev_b32 v9, 1, v9
    v_lshlrev_b32 v8, 3, v8
    v_lshl_add_u32 v8, v9, 4, v8
    v_and_b32 v9, 3, v1
    v_lshl_add_u32 v8, v9, 5, v8
    s_mul_i32 s28, s27, 128
    s_add_u32 s28, s28, 8192
    v_add_u32 v8, s28, v8
    s_mov_b32 exec_lo, 0xf000f
    s_mov_b32 exec_hi, 0xf000f
    ds_write_b64 v8, v[40:41]
    ds_write_b64 v8, v[32:33] offset:512
    s_mov_b64 exec, -1
    s_waitcnt lgkmcnt(0)
.Lt3_c:
    s_barrier
    s_cmp_lg_u32 s20, 4
    s_cbranch_scc1 .Lend
    ds_read_b32 v20, v3 offset:8192
    ds_read_b32 v24, v3 offset:8704
    ds_read_b32 v21, v3 offset:8320
    ds_read_b32 v25, v3 offset:8832
    ds_read_b32 v22, v3 offset:8448
    ds_read_b32 v26, v3 offset:8960
    ds_read_b32 v23, v3 offset:8576
    ds_read_b32 v27, v3 offset:9088
    s_waitcnt lgkmcnt(0)
    v_add_f32 v20, v20, v21
    v_add_f32 v22, v22, v23
    v_add_f32 v20, v20, v22
    v_cvt_pk_bf16_f32 v8, v20, v20
    v_lshlrev_b32 v20, 16, v8
    v_add_f32 v24, v24, v25
    v_add_f32 v26, v26, v27
    v_add_f32 v24, v24, v26
    v_cvt_pk_bf16_f32 v8, v24, v24
    v_lshlrev_b32 v24, 16, v8
    v_mov_b32 v11, 0x200
    v_mul_f32 v8, 0xbfb8aa3b, v20
    v_exp_f32 v8, v8
    s_nop 0
    v_add_f32 v8, 1.0, v8
    v_cmp_class_f32 vcc, v8, v11
    v_rcp_f32 v9, v8
    s_nop 0
    v_mul_f32 v10, v20, v9
    v_fma_f32 v8, -v10, v8, v20
    v_fma_f32 v20, v8, v9, v10
    v_cndmask_b32 v20, v20, v10, vcc
    v_cvt_pk_bf16_f32 v8, v20, v20
    v_lshlrev_b32 v20, 16, v8
    v_mul_f32 v20, v20, v24
    v_cvt_pk_bf16_f32 v8, v20, v20
    v_lshlrev_b32 v20, 16, v8
    v_mov_b32 v8, 0x7fc00000
    v_cmp_eq_u32 vcc, -1, v20
    s_nop 1
    v_cndmask_b32 v20, v20, v8, vcc
    s_sub_u32 s28, s2, 160
    s_lshl_b32 s28, s28, 7
    s_add_u32 s28, s28, 499712
    s_mov_b64 exec, 0xffffffff
    buffer_store_dword v20, v3, s[8:11], s28 offen sc0 sc1
    s_mov_b64 exec, -1
    s_branch .Lend
.Lt4:
    s_cmp_ge_u32 s2, 248
    s_cbranch_scc1 .Lend
    s_cmp_lt_u32 s20, 4
    s_cbranch_scc1 .Lt4_s
    s_mov_b32 s44, s72
    s_mov_b32 s45, s73
    s_mov_b32 s46, 1280
    s_mov_b32 s47, 0x00020000
    s_sub_u32 s31, s2, 208
    s_lshl_b32 s31, s31, 4
    v_and_b32 v6, 15, v1
    v_add_u32 v6, s31, v6
    v_lshlrev_b32 v7, 1, v6
    v_lshlrev_b32 v6, 2, v6
    buffer_load_ushort v10, v7, s[44:47], 0 offen
    s_mov_b32 s39, 0
.poll_48:
    s_mov_b32 s29, 5120
    buffer_load_dword v12, v6, s[8:11], s29 offen sc1
    s_mov_b32 s29, 12800
    buffer_load_dword v13, v6, s[8:11], s29 offen sc1
    s_mov_b32 s29, 458752
    buffer_load_dword v20, v6, s[8:11], s29 offen sc1
    s_mov_b32 s29, 461312
    buffer_load_dword v21, v6, s[8:11], s29 offen sc1
    s_mov_b32 s29, 463872
    buffer_load_dword v22, v6, s[8:11], s29 offen sc1
    s_mov_b32 s29, 466432
    buffer_load_dword v23, v6, s[8:11], s29 offen sc1
    s_mov_b32 s29, 468992
    buffer_load_dword v24, v6, s[8:11], s29 offen sc1
    s_mov_b32 s29, 471552
    buffer_load_dword v25, v6, s[8:11], s29 offen sc1
    s_mov_b32 s29, 474112
    buffer_load_dword v26, v6, s[8:11], s29 offen sc1
    s_mov_b32 s29, 476672
    buffer_load_dword v27, v6, s[8:11], s29 offen sc1
    s_mov_b32 s29, 479232
    buffer_load_dword v28, v6, s[8:11], s29 offen sc1
    s_mov_b32 s29, 481792
    buffer_load_dword v29, v6, s[8:11], s29 offen sc1
    s_mov_b32 s29, 484352
    buffer_load_dword v30, v6, s[8:11], s29 offen sc1
    s_mov_b32 s29, 486912
    buffer_load_dword v31, v6, s[8:11], s29 offen sc1
    s_mov_b32 s29, 489472
    buffer_load_dword v32, v6, s[8:11], s29 offen sc1
    s_mov_b32 s29, 492032
    buffer_load_dword v33, v6, s[8:11], s29 offen sc1
    s_mov_b32 s29, 494592
    buffer_load_dword v34, v6, s[8:11], s29 offen sc1
    s_mov_b32 s29, 497152
    buffer_load_dword v35, v6, s[8:11], s29 offen sc1
    s_waitcnt vmcnt(0)
    v_mov_b32 v53, v12
    v_max3_u32 v53, v53, v13, v20
    v_max3_u32 v53, v53, v21, v22
    v_max3_u32 v53, v53, v23, v24
    v_max3_u32 v53, v53, v25, v26
    v_max3_u32 v53, v53, v27, v28
    v_max3_u32 v53, v53, v29, v30
    v_max3_u32 v53, v53, v31, v32
    v_max3_u32 v53, v53, v33, v34
    v_max_u32 v53, v53, v35
    v_cmp_eq_u32 vcc, -1, v53
    s_cbranch_vccz .polld_49
    s_add_u32 s39, s39, 1
    s_cmp_gt_u32 s39, 400000
    s_cbranch_scc1 .polld_49
    s_sleep 1
    s_branch .poll_48
.polld_49:
    v_add_f32 v20, v20, v21
    v_add_f32 v20, v20, v22
    v_add_f32 v20, v20, v23
    v_add_f32 v20, v20, v24
    v_add_f32 v20, v20, v25
    v_add_f32 v20, v20, v26
    v_add_f32 v20, v20, v27
    v_add_f32 v20, v20, v28
    v_add_f32 v20, v20, v29
    v_add_f32 v20, v20, v30
    v_add_f32 v20, v20, v31
    v_add_f32 v20, v20, v32
    v_add_f32 v20, v20, v33
    v_add_f32 v20, v20, v34
    v_add_f32 v20, v20, v35
    v_cvt_pk_bf16_f32 v8, v20, v20
    v_lshlrev_b32 v20, 16, v8
    v_mul_f32 v20, v20, v12
    v_cvt_pk_bf16_f32 v8, v20, v20
    v_lshlrev_b32 v20, 16, v8
    v_lshlrev_b32 v10, 16, v10
    v_add_f32 v10, v10, v20
    v_cvt_pk_bf16_f32 v8, v10, v10
    v_lshlrev_b32 v10, 16, v8
    v_lshrrev_b32 v8, 1, v1
    s_mul_i32 s28, s27, 384
    v_add_u32 v8, s28, v8
    v_lshlrev_b32 v14, 2, v8
    s_mov_b32 s28, 499712
    s_mov_b32 s39, 0
.poll_50:
    buffer_load_dword v20, v14, s[8:11], s28 offen offset:0 sc1
    buffer_load_dword v21, v14, s[8:11], s28 offen offset:128 sc1
    buffer_load_dword v22, v14, s[8:11], s28 offen offset:256 sc1
    buffer_load_dword v23, v14, s[8:11], s28 offen offset:384 sc1
    buffer_load_dword v24, v14, s[8:11], s28 offen offset:512 sc1
    buffer_load_dword v25, v14, s[8:11], s28 offen offset:640 sc1
    buffer_load_dword v26, v14, s[8:11], s28 offen offset:768 sc1
    buffer_load_dword v27, v14, s[8:11], s28 offen offset:896 sc1
    buffer_load_dword v28, v14, s[8:11], s28 offen offset:1024 sc1
    buffer_load_dword v29, v14, s[8:11], s28 offen offset:1152 sc1
    buffer_load_dword v30, v14, s[8:11], s28 offen offset:1280 sc1
    buffer_load_dword v31, v14, s[8:11], s28 offen offset:1408 sc1
    s_waitcnt vmcnt(0)
    v_mov_b32 v53, v20
    v_max3_u32 v53, v53, v21, v22
    v_max3_u32 v53, v53, v23, v24
    v_max3_u32 v53, v53, v25, v26
    v_max3_u32 v53, v53, v27, v28
    v_max3_u32 v53, v53, v29, v30
    v_max_u32 v53, v53, v31
    v_cmp_eq_u32 vcc, -1, v53
    s_cbranch_vccz .polld_51
    s_add_u32 s39, s39, 1
    s_cmp_gt_u32 s39, 400000
    s_cbranch_scc1 .polld_51
    s_sleep 1
    s_branch .poll_50
.polld_51:
    v_lshlrev_b32 v8, 16, v64
    v_and_b32 v9, 0xffff0000, v64
    v_mul_f32 v40, v20, v8
    v_mul_f32 v41, v20, v9
    v_lshlrev_b32 v8, 16, v65
    v_and_b32 v9, 0xffff0000, v65
    v_mul_f32 v42, v20, v8
    v_mul_f32 v43, v20, v9
    v_lshlrev_b32 v8, 16, v66
    v_and_b32 v9, 0xffff0000, v66
    v_mul_f32 v44, v20, v8
    v_mul_f32 v45, v20, v9
    v_lshlrev_b32 v8, 16, v67
    v_and_b32 v9, 0xffff0000, v67
    v_mul_f32 v46, v20, v8
    v_mul_f32 v47, v20, v9
    v_lshlrev_b32 v8, 16, v68
    v_and_b32 v9, 0xffff0000, v68
    v_fmac_f32 v40, v21, v8
    v_fmac_f32 v41, v21, v9
    v_lshlrev_b32 v8, 16, v69
    v_and_b32 v9, 0xffff0000, v69
    v_fmac_f32 v42, v21, v8
    v_fmac_f32 v43, v21, v9
    v_lshlrev_b32 v8, 16, v70
    v_and_b32 v9, 0xffff0000, v70
    v_fmac_f32 v44, v21, v8
    v_fmac_f32 v45, v21, v9
    v_lshlrev_b32 v8, 16, v71
    v_and_b32 v9, 0xffff0000, v71
    v_fmac_f32 v46, v21, v8
    v_fmac_f32 v47, v21, v9
    v_lshlrev_b32 v8, 16, v72
    v_and_b32 v9, 0xffff0000, v72
    v_fmac_f32 v40, v22, v8
    v_fmac_f32 v41, v22, v9
    v_lshlrev_b32 v8, 16, v73
    v_and_b32 v9, 0xffff0000, v73
    v_fmac_f32 v42, v22, v8
    v_fmac_f32 v43, v22, v9
    v_lshlrev_b32 v8, 16, v74
    v_and_b32 v9, 0xffff0000, v74
    v_fmac_f32 v44, v22, v8
    v_fmac_f32 v45, v22, v9
    v_lshlrev_b32 v8, 16, v75
    v_and_b32 v9, 0xffff0000, v75
    v_fmac_f32 v46, v22, v8
    v_fmac_f32 v47, v22, v9
    v_lshlrev_b32 v8, 16, v76
    v_and_b32 v9, 0xffff0000, v76
    v_fmac_f32 v40, v23, v8
    v_fmac_f32 v41, v23, v9
    v_lshlrev_b32 v8, 16, v77
    v_and_b32 v9, 0xffff0000, v77
    v_fmac_f32 v42, v23, v8
    v_fmac_f32 v43, v23, v9
    v_lshlrev_b32 v8, 16, v78
    v_and_b32 v9, 0xffff0000, v78
    v_fmac_f32 v44, v23, v8
    v_fmac_f32 v45, v23, v9
    v_lshlrev_b32 v8, 16, v79
    v_and_b32 v9, 0xffff0000, v79
    v_fmac_f32 v46, v23, v8
    v_fmac_f32 v47, v23, v9
    v_lshlrev_b32 v8, 16, v80
    v_and_b32 v9, 0xffff0000, v80
    v_fmac_f32 v40, v24, v8
    v_fmac_f32 v41, v24, v9
    v_lshlrev_b32 v8, 16, v81
    v_and_b32 v9, 0xffff0000, v81
    v_fmac_f32 v42, v24, v8
    v_fmac_f32 v43, v24, v9
    v_lshlrev_b32 v8, 16, v82
    v_and_b32 v9, 0xffff0000, v82
    v_fmac_f32 v44, v24, v8
    v_fmac_f32 v45, v24, v9
    v_lshlrev_b32 v8, 16, v83
    v_and_b32 v9, 0xffff0000, v83
    v_fmac_f32 v46, v24, v8
    v_fmac_f32 v47, v24, v9
    v_lshlrev_b32 v8, 16, v84
    v_and_b32 v9, 0xffff0000, v84
    v_fmac_f32 v40, v25, v8
    v_fmac_f32 v41, v25, v9
    v_lshlrev_b32 v8, 16, v85
    v_and_b32 v9, 0xffff0000, v85
    v_fmac_f32 v42, v25, v8
    v_fmac_f32 v43, v25, v9
    v_lshlrev_b32 v8, 16, v86
    v_and_b32 v9, 0xffff0000, v86
    v_fmac_f32 v44, v25, v8
    v_fmac_f32 v45, v25, v9
    v_lshlrev_b32 v8, 16, v87
    v_and_b32 v9, 0xffff0000, v87
    v_fmac_f32 v46, v25, v8
    v_fmac_f32 v47, v25, v9
    v_lshlrev_b32 v8, 16, v88
    v_and_b32 v9, 0xffff0000, v88
    v_fmac_f32 v40, v26, v8
    v_fmac_f32 v41, v26, v9
    v_lshlrev_b32 v8, 16, v89
    v_and_b32 v9, 0xffff0000, v89
    v_fmac_f32 v42, v26, v8
    v_fmac_f32 v43, v26, v9
    v_lshlrev_b32 v8, 16, v90
    v_and_b32 v9, 0xffff0000, v90
    v_fmac_f32 v44, v26, v8
    v_fmac_f32 v45, v26, v9
    v_lshlrev_b32 v8, 16, v91
    v_and_b32 v9, 0xffff0000, v91
    v_fmac_f32 v46, v26, v8
    v_fmac_f32 v47, v26, v9
    v_lshlrev_b32 v8, 16, v92
    v_and_b32 v9, 0xffff0000, v92
    v_fmac_f32 v40, v27, v8
    v_fmac_f32 v41, v27, v9
    v_lshlrev_b32 v8, 16, v93
    v_and_b32 v9, 0xffff0000, v93
    v_fmac_f32 v42, v27, v8
    v_fmac_f32 v43, v27, v9
    v_lshlrev_b32 v8, 16, v94
    v_and_b32 v9, 0xffff0000, v94
    v_fmac_f32 v44, v27, v8
    v_fmac_f32 v45, v27, v9
    v_lshlrev_b32 v8, 16, v95
    v_and_b32 v9, 0xffff0000, v95
    v_fmac_f32 v46, v27, v8
    v_fmac_f32 v47, v27, v9
    v_lshlrev_b32 v8, 16, v96
    v_and_b32 v9, 0xffff0000, v96
    v_fmac_f32 v40, v28, v8
    v_fmac_f32 v41, v28, v9
    v_lshlrev_b32 v8, 16, v97
    v_and_b32 v9, 0xffff0000, v97
    v_fmac_f32 v42, v28, v8
    v_fmac_f32 v43, v28, v9
    v_lshlrev_b32 v8, 16, v98
    v_and_b32 v9, 0xffff0000, v98
    v_fmac_f32 v44, v28, v8
    v_fmac_f32 v45, v28, v9
    v_lshlrev_b32 v8, 16, v99
    v_and_b32 v9, 0xffff0000, v99
    v_fmac_f32 v46, v28, v8
    v_fmac_f32 v47, v28, v9
    v_lshlrev_b32 v8, 16, v100
    v_and_b32 v9, 0xffff0000, v100
    v_fmac_f32 v40, v29, v8
    v_fmac_f32 v41, v29, v9
    v_lshlrev_b32 v8, 16, v101
    v_and_b32 v9, 0xffff0000, v101
    v_fmac_f32 v42, v29, v8
    v_fmac_f32 v43, v29, v9
    v_lshlrev_b32 v8, 16, v102
    v_and_b32 v9, 0xffff0000, v102
    v_fmac_f32 v44, v29, v8
    v_fmac_f32 v45, v29, v9
    v_lshlrev_b32 v8, 16, v103
    v_and_b32 v9, 0xffff0000, v103
    v_fmac_f32 v46, v29, v8
    v_fmac_f32 v47, v29, v9
    v_lshlrev_b32 v8, 16, v104
    v_and_b32 v9, 0xffff0000, v104
    v_fmac_f32 v40, v30, v8
    v_fmac_f32 v41, v30, v9
    v_lshlrev_b32 v8, 16, v105
    v_and_b32 v9, 0xffff0000, v105
    v_fmac_f32 v42, v30, v8
    v_fmac_f32 v43, v30, v9
    v_lshlrev_b32 v8, 16, v106
    v_and_b32 v9, 0xffff0000, v106
    v_fmac_f32 v44, v30, v8
    v_fmac_f32 v45, v30, v9
    v_lshlrev_b32 v8, 16, v107
    v_and_b32 v9, 0xffff0000, v107
    v_fmac_f32 v46, v30, v8
    v_fmac_f32 v47, v30, v9
    v_lshlrev_b32 v8, 16, v108
    v_and_b32 v9, 0xffff0000, v108
    v_fmac_f32 v40, v31, v8
    v_fmac_f32 v41, v31, v9
    v_lshlrev_b32 v8, 16, v109
    v_and_b32 v9, 0xffff0000, v109
    v_fmac_f32 v42, v31, v8
    v_fmac_f32 v43, v31, v9
    v_lshlrev_b32 v8, 16, v110
    v_and_b32 v9, 0xffff0000, v110
    v_fmac_f32 v44, v31, v8
    v_fmac_f32 v45, v31, v9
    v_lshlrev_b32 v8, 16, v111
    v_and_b32 v9, 0xffff0000, v111
    v_fmac_f32 v46, v31, v8
    v_fmac_f32 v47, v31, v9
    s_nop 1
    v_permlane32_swap_b32 v40, v44
    v_permlane32_swap_b32 v41, v45
    v_permlane32_swap_b32 v42, v46
    v_permlane32_swap_b32 v43, v47
    v_add_f32 v40, v40, v44
    v_add_f32 v41, v41, v45
    v_add_f32 v42, v42, v46
    v_add_f32 v43, v43, v47
    s_nop 1
    v_permlane16_swap_b32 v40, v42
    v_permlane16_swap_b32 v41, v43
    v_add_f32 v40, v40, v42
    v_add_f32 v41, v41, v43
    s_nop 1
    v_add_f32_dpp v40, v40, v40 row_ror:2 row_mask:0xf bank_mask:0xf
    v_add_f32_dpp v41, v41, v41 row_ror:2 row_mask:0xf bank_mask:0xf
    s_nop 1
    v_add_f32_dpp v40, v40, v40 row_ror:4 row_mask:0xf bank_mask:0xf
    v_add_f32_dpp v41, v41, v41 row_ror:4 row_mask:0xf bank_mask:0xf
    s_nop 1
    v_add_f32_dpp v40, v40, v40 row_ror:8 row_mask:0xf bank_mask:0xf
    v_add_f32_dpp v41, v41, v41 row_ror:8 row_mask:0xf bank_mask:0xf
    v_lshrrev_b32 v9, 4, v1
    v_and_b32 v8, 1, v9
    v_lshrrev_b32 v9, 1, v9
    v_lshlrev_b32 v8, 3, v8
    v_lshl_add_u32 v8, v9, 4, v8
    v_and_b32 v9, 1, v1
    v_lshl_add_u32 v8, v9, 5, v8
    s_mul_i32 s28, s27, 64
    s_add_u32 s28, s28, 0
    v_add_u32 v8, s28, v8
    s_mov_b32 exec_lo, 0x30003
    s_mov_b32 exec_hi, 0x30003
    ds_write_b64 v8, v[40:41]
    s_mov_b64 exec, -1
    s_waitcnt lgkmcnt(0)
.Lt4_s:
    s_barrier
    s_cmp_lg_u32 s20, 4
    s_cbranch_scc1 .Lend
    v_and_b32 v8, 15, v1
    v_lshlrev_b32 v8, 2, v8
    ds_read_b32 v20, v8 offset:0
    ds_read_b32 v21, v8 offset:64
    ds_read_b32 v22, v8 offset:128
    ds_read_b32 v23, v8 offset:192
    s_waitcnt lgkmcnt(0)
    v_add_f32 v20, v20, v21
    v_add_f32 v22, v22, v23
    v_add_f32 v20, v20, v22
    v_cvt_pk_bf16_f32 v9, v20, v20
    v_lshlrev_b32 v20, 16, v9
    v_mul_f32 v20, v20, v13
    v_cvt_pk_bf16_f32 v9, v20, v20
    v_lshlrev_b32 v20, 16, v9
    v_add_f32 v20, v20, v10
    v_cvt_pk_bf16_f32 v20, v20, v20
    s_mov_b32 s68, s94
    s_mov_b32 s69, s95
    s_mov_b32 s70, 1280
    s_mov_b32 s71, 0x00020000
    s_mov_b64 exec, 0xffff
    buffer_store_short v20, v7, s[68:71], 0 offen
    s_mov_b64 exec, -1
.Lend:
    s_endpgm
.section .rodata,"a"
.p2align 6
.amdhsa_kernel adaLN_cond__mha_block_cached__swiglu_ffn__decode_kernel
  .amdhsa_next_free_vgpr 256
  .amdhsa_next_free_sgpr 102
  .amdhsa_accum_offset 256
  .amdhsa_group_segment_fixed_size 0
  .amdhsa_kernarg_size 112
  .amdhsa_user_sgpr_count 2
  .amdhsa_user_sgpr_kernarg_segment_ptr 1
  .amdhsa_system_sgpr_workgroup_id_x 1
.end_amdhsa_kernel
```
